```python
import torch

def _softmax(x, axis=-1):
    return torch.softmax(x, dim=axis)
def _gelu(x):
    return torch.nn.functional.gelu(x, approximate="tanh")
def _silu(x):
    return torch.nn.functional.silu(x)
def _sigmoid(x):
    return torch.sigmoid(x)
def _layernorm(x, axis=-1, eps=1e-5):
    m = x.mean(dim=axis, keepdim=True)
    v = x.var(dim=axis, keepdim=True, unbiased=False)
    return (x - m) / torch.sqrt(v + eps)
def _scatter_add(tgt, idx, src, axis=0):
    return tgt.clone().index_add_(axis, idx, src)
def _segment_sum(src, seg, n):
    out = torch.zeros((n,) + src.shape[1:], dtype=src.dtype)
    return out.index_add_(0, seg, src)
def _pad(x, pw):
    flat = tuple(v for pair in reversed(pw) for v in pair)
    return torch.nn.functional.pad(x, flat)

kernel_name = 'parallel_sum__sliding_block_cached__geglu_ffn__decode'

def setup_inputs():

    _w = (lambda a: (lambda t: t.to(torch.bfloat16) if t.is_floating_point() else t)(torch.as_tensor(a)))
    def _A_setup():
        B, Sq, D = 4, 1, 640
        Hq, Hkv, Sk, Dh = 32, 32, 8192, 192
        assert Hq % Hkv == 0, (Hq, Hkv)
        return {
            "x": _w((lambda *s: torch.randn(*s, dtype=torch.bfloat16) * 0.05)(B, Sq, D)),
            "k_cache": _w((lambda *s: torch.randn(*s, dtype=torch.bfloat16) * 3.2)(B, Hkv, Sk, Dh)),
            "v_cache": _w((lambda *s: torch.randn(*s, dtype=torch.bfloat16) * 1.6)(B, Hkv, Sk, Dh)),
            "wq": _w((lambda *s: torch.randn(*s, dtype=torch.bfloat16) * 3.2)(D, Hq * Dh) * (D ** -0.5)),
            "wo": _w((lambda *s: torch.randn(*s, dtype=torch.bfloat16) * 1.6)(Hq * Dh, D) * ((Hq * Dh) ** -0.5)),
        }
    _A_in = _A_setup()

    def _B_setup():
        B, S, D, F = 4, 1, 640, 1536
        return {
            "x": _w((lambda *s: torch.randn(*s, dtype=torch.bfloat16) * 0.05)(B, S, D)),
            "w_gate": _w((lambda *s: torch.randn(*s, dtype=torch.bfloat16) * 0.05)(D, F)),
            "w_up": _w((lambda *s: torch.randn(*s, dtype=torch.bfloat16) * 0.05)(D, F)),
            "w_down": _w((lambda *s: torch.randn(*s, dtype=torch.bfloat16) * 0.05)(F, D)),
        }
    _B_in = _B_setup()

    return {
        "A_x": _A_in["x"],
        "A_k_cache": _A_in["k_cache"],
        "A_v_cache": _A_in["v_cache"],
        "A_wq": _A_in["wq"],
        "A_wo": _A_in["wo"],
        "B_x": _B_in["x"],
        "B_w_gate": _B_in["w_gate"],
        "B_w_up": _B_in["w_up"],
        "B_w_down": _B_in["w_down"],
    }

def reference(A_x, A_k_cache, A_v_cache, A_wq, A_wo, B_x, B_w_gate, B_w_up, B_w_down):
    def _A_ref(x, k_cache, v_cache, wq, wo):
        B, Sq, D = x.shape
        Hq, Dh = 32, 192
        Hkv, Sk = k_cache.shape[1], k_cache.shape[2]
        W = min(4096, max(256, Sk // 4))
        rep = Hq // Hkv
        q = (lambda x, *d: x.permute(*d))((x @ wq).reshape(B, Sq, Hq, Dh), 0, 2, 1, 3)
        k = (lambda x, n, axis: torch.repeat_interleave(x, n, dim=axis))(k_cache[:, :, Sk - W:, :], rep, axis=1)
        v = (lambda x, n, axis: torch.repeat_interleave(x, n, dim=axis))(v_cache[:, :, Sk - W:, :], rep, axis=1)
        scores = torch.einsum("bhqd,bhkd->bhqk", q, k) * (Dh ** -0.5)
        p = _softmax(scores, axis=-1)
        o = torch.einsum("bhqk,bhkd->bhqd", p, v)
        return (lambda x, *d: x.permute(*d))(o, 0, 2, 1, 3).reshape(B, Sq, Hq * Dh) @ wo

    def _B_ref(x, w_gate, w_up, w_down):
        return (_gelu(x @ w_gate) * (x @ w_up)) @ w_down

    x = A_x
    xn = _layernorm(x, axis=-1)
    return x + _A_ref(xn, A_k_cache, A_v_cache, A_wq, A_wo) + _B_ref(xn, B_w_gate, B_w_up, B_w_down)
```

```asm
; @launch grid=(256,1,1) block=(512,1,1) lds=160768
.amdgcn_target "amdgcn-amd-amdhsa--gfx950"
.text
.globl parallel_sum__sliding_block_cached__geglu_ffn__decode_kernel
.p2align 8
.type parallel_sum__sliding_block_cached__geglu_ffn__decode_kernel,@function
parallel_sum__sliding_block_cached__geglu_ffn__decode_kernel:
  s_load_dwordx2 s[8:9], s[0:1], 8
  s_load_dwordx16 s[44:59], s[0:1], 0
  s_cmp_ge_u32 s2, 256
  s_cbranch_scc1 L_end
  v_lshrrev_b32 v14, 6, v0
  v_bfe_u32 v20, v0, 2, 2
  v_readfirstlane_b32 s3, v14
  v_and_b32 v21, 3, v0
  v_lshlrev_b32 v21, 4, v21
  v_mul_u32_u24 v9, 1536, v20
  v_bfe_u32 v3, v0, 4, 2
  v_add_u32 v9, v9, v21
  v_lshl_add_u32 v8, v3, 6, v9
  s_and_b32 s68, s2, 7
  s_lshr_b32 s74, s2, 6
  s_lshl2_add_u32 s4, s68, s74
  s_bfe_u32 s5, s2, 0x20004
  s_bfe_u32 s6, s2, 0x10003
  s_lshl_b32 s74, s5, 5
  s_add_u32 s91, s74, s4
  s_lshl3_add_u32 s74, s91, s6
  s_add_u32 s74, s74, 6
  s_lshl_b32 s74, s74, 6
  s_mul_i32 s73, s74, 6144
  s_mul_i32 s67, s4, 845
  s_mul_i32 s74, s5, 64
  s_add_u32 s67, s67, s74
  s_mul_i32 s74, s6, 366
  s_add_u32 s67, s67, s74
  s_lshr_b32 s67, s67, 4
  s_add_u32 s67, s67, s3
  s_and_b32 s67, s67, 63
  s_mul_i32 s71, s67, 6144
  s_add_u32 s71, s71, s73
  s_mov_b32 s10, 402653184
  s_mov_b32 s11, 0x20000
  s_waitcnt lgkmcnt(0)
  buffer_load_dwordx4 v[64:67], v8, s[8:11], s71 offen offset:0 nt
  buffer_load_dwordx4 v[68:71], v8, s[8:11], s71 offen offset:384 nt
  s_load_dwordx2 s[24:25], s[0:1], 64
  s_load_dwordx2 s[36:37], s[0:1], 72
  s_load_dwordx2 s[32:33], s[0:1], 88
  v_and_b32 v1, 63, v0
  v_and_b32 v2, 15, v1
  v_lshlrev_b32 v20, 4, v1
  s_mov_b32 s28, s44
  s_mov_b32 s29, s45
  s_movk_i32 s30, 5120
  s_mov_b32 s31, 0x20000
  s_lshl_b32 s74, s3, 10
  s_add_u32 m0, s74, 16128
  s_cmp_ge_u32 s3, 5
  s_cbranch_scc1 L_nox
  buffer_load_dwordx4 v20, s[28:31], s74 offen lds
L_nox:
  s_lshr_b32 s76, s2, 6
  s_lshl2_add_u32 s76, s5, s76
  s_and_b32 s77, s2, 15
  s_lshl4_add_u32 s66, s76, s77
  s_mul_i32 s93, s66, 911
  s_lshr_b32 s93, s93, 16
  s_mul_i32 s77, s93, 72
  s_sub_u32 s92, s66, s77
  s_mul_i32 s97, s93, 224
  s_lshl_b32 s76, s3, 5
  s_add_u32 s97, s97, s76
  s_sub_u32 s76, s92, 48
  s_sub_u32 s77, s92, 60
  s_cmp_lt_u32 s92, 60
  s_cselect_b32 s16, s56, s58
  s_cselect_b32 s17, s57, s59
  s_cselect_b32 s98, s76, s77
  s_movk_i32 s96, 3072
  s_mov_b32 s18, 1966080
  s_cmp_lt_u32 s92, 48
  s_cselect_b32 s16, s50, s16
  s_cselect_b32 s17, s51, s17
  s_cselect_b32 s18, 7864320, s18
  s_cselect_b32 s96, 12288, s96
  s_cselect_b32 s98, s92, s98
  s_and_b32 s17, s17, 0xffff
  s_mov_b32 s19, 0x20000
  s_mul_i32 s94, s97, s96
  s_lshl_b32 s98, s98, 8
  s_add_u32 s94, s94, s98
  s_cmp_eq_u32 s3, 7
  s_cselect_b32 s94, 1073741824, s94
  s_cmp_ge_u32 s66, 216
  s_cselect_b32 s94, 1073741824, s94
  v_mul_lo_u32 v16, v3, s96
  v_lshl_add_u32 v16, v2, 4, v16
  s_lshl_b32 s96, s96, 2
  v_lshrrev_b32 v22, 1, v3
  v_mul_u32_u24 v21, 384, v22
  v_add_u32 v9, v9, v21
  v_and_b32 v22, 1, v3
  v_lshlrev_b32 v22, 6, v22
  v_add3_u32 v9, v9, v22, 64
  v_add_u32 v9, 192, v9
  buffer_load_dwordx4 v[224:227], v16, s[16:19], s94 offen nt
  s_add_u32 s94, s94, s96
  buffer_load_dwordx4 v[228:231], v16, s[16:19], s94 offen nt
  s_add_u32 s94, s94, s96
  buffer_load_dwordx4 v[232:235], v16, s[16:19], s94 offen nt
  s_add_u32 s94, s94, s96
  buffer_load_dwordx4 v[236:239], v16, s[16:19], s94 offen nt
  s_add_u32 s94, s94, s96
  buffer_load_dwordx4 v[240:243], v16, s[16:19], s94 offen nt
  s_add_u32 s94, s94, s96
  buffer_load_dwordx4 v[244:247], v16, s[16:19], s94 offen nt
  s_add_u32 s94, s94, s96
  buffer_load_dwordx4 v[248:251], v16, s[16:19], s94 offen nt
  s_add_u32 s94, s94, s96
  buffer_load_dwordx4 v[252:255], v16, s[16:19], s94 offen nt
  s_waitcnt lgkmcnt(0)
  s_load_dwordx2 s[100:101], s[32:33], 983040
  s_mov_b32 s34, 4194304
  s_mov_b32 s35, 0x20000
  s_mov_b32 s26, 1966080
  s_mov_b32 s27, 0x20000
  s_movk_i32 s38, 5120
  s_mov_b32 s39, 0x20000
  s_mov_b32 s12, s48
  s_and_b32 s13, s49, 0xffff
  s_mov_b32 s14, 402653184
  s_mov_b32 s15, 0x20000
  s_mov_b32 s20, s52
  s_and_b32 s21, s53, 0xffff
  s_mov_b32 s22, 7864320
  s_mov_b32 s23, 0x20000
  s_bfe_u32 s77, s2, 0x30003
  s_lshl3_add_u32 s76, s4, s77
  s_mul_i32 s74, s76, 30720
  s_mul_i32 s77, s3, 3840
  s_add_u32 s74, s74, s77
  v_lshlrev_b32 v62, 7, v1
  s_mov_b64 exec, 0x3fffffff
  buffer_load_dword v63, v62, s[20:23], s74 offen
  s_mov_b64 exec, -1
  s_bfe_u32 s77, s2, 0x30003
  s_lshl3_add_u32 s76, s4, s77
  s_mul_i32 s74, s76, 7680
  s_mul_i32 s77, s3, 960
  s_add_u32 s74, s74, s77
  v_lshlrev_b32 v62, 7, v1
  s_mov_b64 exec, 0xff
  buffer_load_dword v63, v62, s[24:27], s74 offen
  s_mov_b64 exec, -1
  s_lshl_b32 s69, s4, 1
  s_add_u32 s69, s69, s6
  s_mov_b32 s78, -1
  s_mov_b32 s79, 0
  s_lshl_b32 s74, s5, 6
  s_add_u32 s74, s74, s69
  s_mul_i32 s90, s74, 2560
  s_lshl_b32 s91, s91, 8
  s_add_u32 s91, s91, 1048576
  s_lshl_b32 s76, s6, 7
  s_add_u32 s89, s91, s76
  s_mul_i32 s42, s69, 24
  s_mul_i32 s74, s3, 3
  s_add_u32 s42, s42, s74
  s_mul_i32 s42, s42, 1280
  s_mul_i32 s40, s4, 192
  s_mul_i32 s74, s3, 24
  s_add_u32 s40, s40, s74
  s_mul_i32 s40, s40, 1280
  s_add_u32 s41, s40, 5120
  s_add_u32 s64, s40, 15360
  s_add_u32 s65, s40, 20480
  s_mul_i32 s43, s3, 17408
  s_add_u32 s43, s43, 21504
  v_mov_b32 v17, 1280
  v_mul_u32_u24 v18, 1280, v3
  v_lshl_add_u32 v18, v2, 4, v18
  s_lshl_b32 s97, s97, 1
  s_min_u32 s97, s97, 1216
  v_lshl_add_u32 v19, v3, 1, s97
  v_lshrrev_b32 v14, 3, v2
  v_mad_u32_u24 v19, v14, v17, v19
  v_and_b32 v15, 7, v2
  v_lshlrev_b32 v15, 4, v15
  v_and_b32 v20, 1, v2
  v_cmp_eq_u32 vcc, 1, v20
  v_mov_b32 v21, 0xffff
  v_mov_b32 v22, 0xffff0000
  v_cndmask_b32 v21, v21, v22, vcc
  v_bfe_u32 v20, v2, 1, 2
  v_cmp_eq_u32 vcc, 0, v20
  s_nop 1
  v_cndmask_b32 v4, 0, v21, vcc
  v_cmp_eq_u32 vcc, 1, v20
  s_nop 1
  v_cndmask_b32 v5, 0, v21, vcc
  v_cmp_eq_u32 vcc, 2, v20
  s_nop 1
  v_cndmask_b32 v6, 0, v21, vcc
  v_cmp_eq_u32 vcc, 3, v20
  s_nop 1
  v_cndmask_b32 v7, 0, v21, vcc
  v_mul_u32_u24 v10, 384, v3
  v_lshrrev_b32 v20, 3, v2
  v_mul_u32_u24 v11, 3072, v20
  v_add3_u32 v11, v11, v10, v15
  v_add_u32 v11, 256, v11
  v_lshl_add_u32 v10, v2, 4, v10
  v_lshrrev_b32 v12, 1, v3
  v_mul_u32_u24 v12, 5120, v12
  v_add_u32 v12, v12, v18
  v_mov_b32 v22, 1073741824
  v_cmp_eq_u32 vcc, 3, v3
  s_nop 1
  v_cndmask_b32 v13, v18, v22, vcc
  v_lshrrev_b32 v20, 1, v3
  v_lshlrev_b32 v20, 9, v20
  v_and_b32 v22, 1, v3
  v_lshl_add_u32 v22, v22, 4, v20
  v_lshl_add_u32 v22, v2, 5, v22
  s_lshl_b32 s74, s3, 11
  v_add_u32 v22, s74, v22
  v_mov_b32 v20, 16000
  v_mov_b32 v21, 0
  ds_write_b32 v20, v21
  ds_write_b32 v20, v21 offset:4
  s_waitcnt lgkmcnt(0)
  s_mul_i32 s100, s100, 0x9E3779B1
  s_add_u32 s100, s100, 0x7F4A7C15
  s_mul_i32 s101, s101, 0x85EBCA69
  s_add_u32 s101, s101, 0xC2B2AE35
  s_and_b32 s70, s100, 0xff
  s_and_b32 s7, s101, 0xff
  s_waitcnt vmcnt(10)
  s_barrier
  ds_read_b128 v[24:27], v18 offset:16128
  ds_read_b128 v[28:31], v18 offset:16384
  ds_read_b128 v[32:35], v18 offset:16640
  ds_read_b128 v[36:39], v18 offset:16896
  ds_read_b128 v[40:43], v18 offset:17152
  ds_read_u16 v168, v19 offset:16128
  ds_read_u16 v169, v19 offset:16136
  ds_read_u16 v170, v19 offset:16144
  ds_read_u16 v171, v19 offset:16152
  ds_read_u16 v172, v19 offset:16160
  ds_read_u16 v173, v19 offset:16168
  ds_read_u16 v174, v19 offset:16176
  ds_read_u16 v175, v19 offset:16184
  ds_read_u16 v176, v19 offset:18688
  ds_read_u16 v177, v19 offset:18696
  ds_read_u16 v178, v19 offset:18704
  ds_read_u16 v179, v19 offset:18712
  ds_read_u16 v180, v19 offset:18720
  ds_read_u16 v181, v19 offset:18728
  ds_read_u16 v182, v19 offset:18736
  ds_read_u16 v183, v19 offset:18744
  buffer_load_dwordx4 v[72:75], v9, s[8:11], s71 offen offset:0 nt
  s_waitcnt lgkmcnt(0)
  v_lshlrev_b32 v184, 16, v24
  v_and_b32 v185, 0xffff0000, v24
  v_lshlrev_b32 v186, 16, v25
  v_and_b32 v187, 0xffff0000, v25
  v_lshlrev_b32 v188, 16, v26
  v_and_b32 v189, 0xffff0000, v26
  v_lshlrev_b32 v190, 16, v27
  v_and_b32 v191, 0xffff0000, v27
  v_lshlrev_b32 v192, 16, v28
  v_and_b32 v193, 0xffff0000, v28
  v_lshlrev_b32 v194, 16, v29
  v_and_b32 v195, 0xffff0000, v29
  v_lshlrev_b32 v196, 16, v30
  v_and_b32 v197, 0xffff0000, v30
  v_lshlrev_b32 v198, 16, v31
  v_and_b32 v199, 0xffff0000, v31
  v_lshlrev_b32 v200, 16, v32
  v_and_b32 v201, 0xffff0000, v32
  v_lshlrev_b32 v202, 16, v33
  v_and_b32 v203, 0xffff0000, v33
  v_lshlrev_b32 v204, 16, v34
  v_and_b32 v205, 0xffff0000, v34
  v_lshlrev_b32 v206, 16, v35
  v_and_b32 v207, 0xffff0000, v35
  v_lshlrev_b32 v208, 16, v36
  v_and_b32 v209, 0xffff0000, v36
  v_lshlrev_b32 v210, 16, v37
  v_and_b32 v211, 0xffff0000, v37
  v_lshlrev_b32 v212, 16, v38
  v_and_b32 v213, 0xffff0000, v38
  v_lshlrev_b32 v214, 16, v39
  v_and_b32 v215, 0xffff0000, v39
  v_lshlrev_b32 v216, 16, v40
  v_and_b32 v217, 0xffff0000, v40
  v_lshlrev_b32 v218, 16, v41
  v_and_b32 v219, 0xffff0000, v41
  v_lshlrev_b32 v220, 16, v42
  v_and_b32 v221, 0xffff0000, v42
  v_lshlrev_b32 v222, 16, v43
  v_and_b32 v223, 0xffff0000, v43
  v_pk_add_f32 v[52:53], v[184:185], v[186:187]
  v_pk_add_f32 v[54:55], v[188:189], v[190:191]
  v_pk_add_f32 v[52:53], v[52:53], v[192:193]
  v_pk_add_f32 v[54:55], v[54:55], v[194:195]
  v_pk_add_f32 v[52:53], v[52:53], v[196:197]
  v_pk_add_f32 v[54:55], v[54:55], v[198:199]
  v_pk_add_f32 v[52:53], v[52:53], v[200:201]
  v_pk_add_f32 v[54:55], v[54:55], v[202:203]
  v_pk_add_f32 v[52:53], v[52:53], v[204:205]
  v_pk_add_f32 v[54:55], v[54:55], v[206:207]
  v_pk_add_f32 v[52:53], v[52:53], v[208:209]
  v_pk_add_f32 v[54:55], v[54:55], v[210:211]
  v_pk_add_f32 v[52:53], v[52:53], v[212:213]
  v_pk_add_f32 v[54:55], v[54:55], v[214:215]
  v_pk_add_f32 v[52:53], v[52:53], v[216:217]
  v_pk_add_f32 v[54:55], v[54:55], v[218:219]
  v_pk_add_f32 v[52:53], v[52:53], v[220:221]
  v_pk_add_f32 v[54:55], v[54:55], v[222:223]
  v_pk_add_f32 v[52:53], v[52:53], v[54:55]
  v_add_f32 v52, v52, v53
  s_nop 1
  v_add_f32_dpp v52, v52, v52 row_ror:8 row_mask:0xf bank_mask:0xf
  s_nop 1
  v_add_f32_dpp v52, v52, v52 row_ror:4 row_mask:0xf bank_mask:0xf
  s_nop 1
  v_add_f32_dpp v52, v52, v52 row_ror:2 row_mask:0xf bank_mask:0xf
  s_nop 1
  v_add_f32_dpp v52, v52, v52 row_ror:1 row_mask:0xf bank_mask:0xf
  v_mul_f32 v56, 0xbacccccd, v52
  buffer_load_dwordx4 v[76:79], v8, s[8:11], s71 offen offset:768 nt
  buffer_load_dwordx4 v[80:83], v8, s[8:11], s71 offen offset:1152 nt
  s_add_u32 m0, s43, 0
  s_nop 0
  buffer_load_dwordx4 v12, s[20:23], s40 offen offset:0 sc1 lds
  v_pk_add_f32 v[184:185], v[184:185], v[56:57] op_sel_hi:[1,0]
  v_pk_add_f32 v[186:187], v[186:187], v[56:57] op_sel_hi:[1,0]
  v_pk_add_f32 v[188:189], v[188:189], v[56:57] op_sel_hi:[1,0]
  v_pk_add_f32 v[190:191], v[190:191], v[56:57] op_sel_hi:[1,0]
  v_pk_add_f32 v[192:193], v[192:193], v[56:57] op_sel_hi:[1,0]
  v_pk_add_f32 v[194:195], v[194:195], v[56:57] op_sel_hi:[1,0]
  v_pk_add_f32 v[196:197], v[196:197], v[56:57] op_sel_hi:[1,0]
  v_pk_add_f32 v[198:199], v[198:199], v[56:57] op_sel_hi:[1,0]
  v_pk_add_f32 v[200:201], v[200:201], v[56:57] op_sel_hi:[1,0]
  v_pk_add_f32 v[202:203], v[202:203], v[56:57] op_sel_hi:[1,0]
  v_pk_add_f32 v[204:205], v[204:205], v[56:57] op_sel_hi:[1,0]
  v_pk_add_f32 v[206:207], v[206:207], v[56:57] op_sel_hi:[1,0]
  v_pk_add_f32 v[208:209], v[208:209], v[56:57] op_sel_hi:[1,0]
  v_pk_add_f32 v[210:211], v[210:211], v[56:57] op_sel_hi:[1,0]
  v_pk_add_f32 v[212:213], v[212:213], v[56:57] op_sel_hi:[1,0]
  v_pk_add_f32 v[214:215], v[214:215], v[56:57] op_sel_hi:[1,0]
  v_pk_add_f32 v[216:217], v[216:217], v[56:57] op_sel_hi:[1,0]
  v_pk_add_f32 v[218:219], v[218:219], v[56:57] op_sel_hi:[1,0]
  v_pk_add_f32 v[220:221], v[220:221], v[56:57] op_sel_hi:[1,0]
  v_pk_add_f32 v[222:223], v[222:223], v[56:57] op_sel_hi:[1,0]
  v_pk_mul_f32 v[52:53], v[184:185], v[184:185]
  v_pk_mul_f32 v[54:55], v[186:187], v[186:187]
  v_pk_fma_f32 v[52:53], v[188:189], v[188:189], v[52:53]
  v_pk_fma_f32 v[54:55], v[190:191], v[190:191], v[54:55]
  v_pk_fma_f32 v[52:53], v[192:193], v[192:193], v[52:53]
  v_pk_fma_f32 v[54:55], v[194:195], v[194:195], v[54:55]
  v_pk_fma_f32 v[52:53], v[196:197], v[196:197], v[52:53]
  v_pk_fma_f32 v[54:55], v[198:199], v[198:199], v[54:55]
  v_pk_fma_f32 v[52:53], v[200:201], v[200:201], v[52:53]
  v_pk_fma_f32 v[54:55], v[202:203], v[202:203], v[54:55]
  v_pk_fma_f32 v[52:53], v[204:205], v[204:205], v[52:53]
  v_pk_fma_f32 v[54:55], v[206:207], v[206:207], v[54:55]
  v_pk_fma_f32 v[52:53], v[208:209], v[208:209], v[52:53]
  v_pk_fma_f32 v[54:55], v[210:211], v[210:211], v[54:55]
  v_pk_fma_f32 v[52:53], v[212:213], v[212:213], v[52:53]
  v_pk_fma_f32 v[54:55], v[214:215], v[214:215], v[54:55]
  v_pk_fma_f32 v[52:53], v[216:217], v[216:217], v[52:53]
  v_pk_fma_f32 v[54:55], v[218:219], v[218:219], v[54:55]
  v_pk_fma_f32 v[52:53], v[220:221], v[220:221], v[52:53]
  v_pk_fma_f32 v[54:55], v[222:223], v[222:223], v[54:55]
  v_pk_add_f32 v[52:53], v[52:53], v[54:55]
  v_add_f32 v52, v52, v53
  s_nop 1
  v_add_f32_dpp v52, v52, v52 row_ror:8 row_mask:0xf bank_mask:0xf
  s_nop 1
  v_add_f32_dpp v52, v52, v52 row_ror:4 row_mask:0xf bank_mask:0xf
  s_nop 1
  v_add_f32_dpp v52, v52, v52 row_ror:2 row_mask:0xf bank_mask:0xf
  s_nop 1
  v_add_f32_dpp v52, v52, v52 row_ror:1 row_mask:0xf bank_mask:0xf
  v_mul_f32 v52, 0x3acccccd, v52
  v_cvt_pk_bf16_f32 v53, v56, v52
  v_lshlrev_b32 v56, 16, v53
  v_and_b32 v52, 0xffff0000, v53
  v_add_f32 v52, 0x3727c5ac, v52
  v_cvt_pk_bf16_f32 v52, v52, v52
  v_and_b32 v52, 0xffff0000, v52
  v_sqrt_f32 v52, v52
  s_nop 0
  v_cvt_pk_bf16_f32 v52, v52, v52
  v_and_b32 v52, 0xffff0000, v52
  v_rcp_f32 v52, v52
  v_lshlrev_b32 v53, 6, v14
  v_add_u32 v54, 128, v53
  ds_bpermute_b32 v58, v53, v56
  ds_bpermute_b32 v60, v54, v56
  ds_bpermute_b32 v24, v53, v52
  ds_bpermute_b32 v26, v54, v52
  buffer_load_dwordx4 v[84:87], v9, s[8:11], s71 offen offset:768 nt
  v_lshlrev_b32 v184, 16, v168
  v_lshlrev_b32 v185, 16, v169
  v_lshlrev_b32 v186, 16, v170
  v_lshlrev_b32 v187, 16, v171
  v_lshlrev_b32 v188, 16, v172
  v_lshlrev_b32 v189, 16, v173
  v_lshlrev_b32 v190, 16, v174
  v_lshlrev_b32 v191, 16, v175
  v_lshlrev_b32 v192, 16, v176
  v_lshlrev_b32 v193, 16, v177
  v_lshlrev_b32 v194, 16, v178
  v_lshlrev_b32 v195, 16, v179
  v_lshlrev_b32 v196, 16, v180
  v_lshlrev_b32 v197, 16, v181
  v_lshlrev_b32 v198, 16, v182
  v_lshlrev_b32 v199, 16, v183
  s_waitcnt lgkmcnt(0)
  v_pk_add_f32 v[184:185], v[184:185], v[58:59] op_sel_hi:[1,0]
  v_pk_add_f32 v[186:187], v[186:187], v[58:59] op_sel_hi:[1,0]
  v_pk_add_f32 v[188:189], v[188:189], v[58:59] op_sel_hi:[1,0]
  v_pk_add_f32 v[190:191], v[190:191], v[58:59] op_sel_hi:[1,0]
  v_pk_add_f32 v[192:193], v[192:193], v[60:61] op_sel_hi:[1,0]
  v_pk_add_f32 v[194:195], v[194:195], v[60:61] op_sel_hi:[1,0]
  v_pk_add_f32 v[196:197], v[196:197], v[60:61] op_sel_hi:[1,0]
  v_pk_add_f32 v[198:199], v[198:199], v[60:61] op_sel_hi:[1,0]
  v_cvt_pk_bf16_f32 v44, v184, v185
  v_cvt_pk_bf16_f32 v45, v186, v187
  v_cvt_pk_bf16_f32 v46, v188, v189
  v_cvt_pk_bf16_f32 v47, v190, v191
  v_cvt_pk_bf16_f32 v48, v192, v193
  v_cvt_pk_bf16_f32 v49, v194, v195
  v_cvt_pk_bf16_f32 v50, v196, v197
  v_cvt_pk_bf16_f32 v51, v198, v199
  v_lshlrev_b32 v184, 16, v44
  v_and_b32 v185, 0xffff0000, v44
  v_lshlrev_b32 v186, 16, v45
  v_and_b32 v187, 0xffff0000, v45
  v_lshlrev_b32 v188, 16, v46
  v_and_b32 v189, 0xffff0000, v46
  v_lshlrev_b32 v190, 16, v47
  v_and_b32 v191, 0xffff0000, v47
  v_lshlrev_b32 v192, 16, v48
  v_and_b32 v193, 0xffff0000, v48
  v_lshlrev_b32 v194, 16, v49
  v_and_b32 v195, 0xffff0000, v49
  v_lshlrev_b32 v196, 16, v50
  v_and_b32 v197, 0xffff0000, v50
  v_lshlrev_b32 v198, 16, v51
  v_and_b32 v199, 0xffff0000, v51
  v_pk_mul_f32 v[184:185], v[184:185], v[24:25] op_sel_hi:[1,0]
  v_pk_mul_f32 v[186:187], v[186:187], v[24:25] op_sel_hi:[1,0]
  v_pk_mul_f32 v[188:189], v[188:189], v[24:25] op_sel_hi:[1,0]
  v_pk_mul_f32 v[190:191], v[190:191], v[24:25] op_sel_hi:[1,0]
  v_pk_mul_f32 v[192:193], v[192:193], v[26:27] op_sel_hi:[1,0]
  v_pk_mul_f32 v[194:195], v[194:195], v[26:27] op_sel_hi:[1,0]
  v_pk_mul_f32 v[196:197], v[196:197], v[26:27] op_sel_hi:[1,0]
  v_pk_mul_f32 v[198:199], v[198:199], v[26:27] op_sel_hi:[1,0]
  v_cvt_pk_bf16_f32 v184, v184, v184
  v_cvt_pk_bf16_f32 v185, v185, v185
  v_cvt_pk_bf16_f32 v186, v186, v186
  v_cvt_pk_bf16_f32 v187, v187, v187
  v_cvt_pk_bf16_f32 v188, v188, v188
  v_cvt_pk_bf16_f32 v189, v189, v189
  v_cvt_pk_bf16_f32 v190, v190, v190
  v_cvt_pk_bf16_f32 v191, v191, v191
  v_cvt_pk_bf16_f32 v192, v192, v192
  v_cvt_pk_bf16_f32 v193, v193, v193
  v_cvt_pk_bf16_f32 v194, v194, v194
  v_cvt_pk_bf16_f32 v195, v195, v195
  v_cvt_pk_bf16_f32 v196, v196, v196
  v_cvt_pk_bf16_f32 v197, v197, v197
  v_cvt_pk_bf16_f32 v198, v198, v198
  v_cvt_pk_bf16_f32 v199, v199, v199
  s_add_u32 s71, s67, 8
  s_and_b32 s71, s71, 63
  s_mul_i32 s71, s71, 6144
  s_add_u32 s71, s71, s73
  buffer_load_dwordx4 v[88:91], v8, s[8:11], s71 offen offset:0 nt
  v_and_b32 v200, v184, v4
  v_and_b32 v201, v184, v5
  v_and_b32 v202, v184, v6
  v_and_b32 v203, v184, v7
  v_and_b32 v204, v192, v4
  v_and_b32 v205, v192, v5
  v_and_b32 v206, v192, v6
  v_and_b32 v207, v192, v7
  s_waitcnt vmcnt(15)
  v_mfma_f32_16x16x32_bf16 v[216:219], v[200:203], v[224:227], 0
  v_mfma_f32_16x16x32_bf16 v[220:223], v[204:207], v[224:227], 0
  v_and_b32 v208, v185, v4
  v_and_b32 v209, v185, v5
  v_and_b32 v210, v185, v6
  v_and_b32 v211, v185, v7
  v_and_b32 v212, v193, v4
  v_and_b32 v213, v193, v5
  v_and_b32 v214, v193, v6
  v_and_b32 v215, v193, v7
  s_waitcnt vmcnt(14)
  v_mfma_f32_16x16x32_bf16 v[216:219], v[208:211], v[228:231], v[216:219]
  v_mfma_f32_16x16x32_bf16 v[220:223], v[212:215], v[228:231], v[220:223]
  v_and_b32 v200, v186, v4
  v_and_b32 v201, v186, v5
  v_and_b32 v202, v186, v6
  v_and_b32 v203, v186, v7
  v_and_b32 v204, v194, v4
  v_and_b32 v205, v194, v5
  v_and_b32 v206, v194, v6
  v_and_b32 v207, v194, v7
  s_waitcnt vmcnt(13)
  v_mfma_f32_16x16x32_bf16 v[216:219], v[200:203], v[232:235], v[216:219]
  v_mfma_f32_16x16x32_bf16 v[220:223], v[204:207], v[232:235], v[220:223]
  v_and_b32 v208, v187, v4
  v_and_b32 v209, v187, v5
  v_and_b32 v210, v187, v6
  v_and_b32 v211, v187, v7
  v_and_b32 v212, v195, v4
  v_and_b32 v213, v195, v5
  v_and_b32 v214, v195, v6
  v_and_b32 v215, v195, v7
  s_waitcnt vmcnt(12)
  v_mfma_f32_16x16x32_bf16 v[216:219], v[208:211], v[236:239], v[216:219]
  v_mfma_f32_16x16x32_bf16 v[220:223], v[212:215], v[236:239], v[220:223]
  buffer_load_dwordx4 v[92:95], v8, s[8:11], s71 offen offset:384 nt
  buffer_load_dwordx4 v[96:99], v9, s[8:11], s71 offen offset:0 nt
  s_add_u32 m0, s43, 1024
  s_nop 0
  buffer_load_dwordx4 v12, s[20:23], s64 offen offset:0 sc1 lds
  v_and_b32 v200, v188, v4
  v_and_b32 v201, v188, v5
  v_and_b32 v202, v188, v6
  v_and_b32 v203, v188, v7
  v_and_b32 v204, v196, v4
  v_and_b32 v205, v196, v5
  v_and_b32 v206, v196, v6
  v_and_b32 v207, v196, v7
  s_waitcnt vmcnt(14)
  v_mfma_f32_16x16x32_bf16 v[216:219], v[200:203], v[240:243], v[216:219]
  v_mfma_f32_16x16x32_bf16 v[220:223], v[204:207], v[240:243], v[220:223]
  v_and_b32 v208, v189, v4
  v_and_b32 v209, v189, v5
  v_and_b32 v210, v189, v6
  v_and_b32 v211, v189, v7
  v_and_b32 v212, v197, v4
  v_and_b32 v213, v197, v5
  v_and_b32 v214, v197, v6
  v_and_b32 v215, v197, v7
  s_waitcnt vmcnt(13)
  v_mfma_f32_16x16x32_bf16 v[216:219], v[208:211], v[244:247], v[216:219]
  v_mfma_f32_16x16x32_bf16 v[220:223], v[212:215], v[244:247], v[220:223]
  v_and_b32 v200, v190, v4
  v_and_b32 v201, v190, v5
  v_and_b32 v202, v190, v6
  v_and_b32 v203, v190, v7
  v_and_b32 v204, v198, v4
  v_and_b32 v205, v198, v5
  v_and_b32 v206, v198, v6
  v_and_b32 v207, v198, v7
  s_waitcnt vmcnt(12)
  v_mfma_f32_16x16x32_bf16 v[216:219], v[200:203], v[248:251], v[216:219]
  v_mfma_f32_16x16x32_bf16 v[220:223], v[204:207], v[248:251], v[220:223]
  v_and_b32 v208, v191, v4
  v_and_b32 v209, v191, v5
  v_and_b32 v210, v191, v6
  v_and_b32 v211, v191, v7
  v_and_b32 v212, v199, v4
  v_and_b32 v213, v199, v5
  v_and_b32 v214, v199, v6
  v_and_b32 v215, v199, v7
  s_waitcnt vmcnt(11)
  v_mfma_f32_16x16x32_bf16 v[216:219], v[208:211], v[252:255], v[216:219]
  v_mfma_f32_16x16x32_bf16 v[220:223], v[212:215], v[252:255], v[220:223]
  buffer_load_dwordx4 v[100:103], v8, s[8:11], s71 offen offset:768 nt
  s_cmp_eq_u32 s3, 7
  s_cbranch_scc1 L_nopart
  s_nop 3
  ds_write_b128 v22, v[216:219] offset:0
  ds_write_b128 v22, v[220:223] offset:1024
L_nopart:
  s_waitcnt lgkmcnt(0)
  s_barrier
  s_cmp_lt_u32 s3, 6
  s_cbranch_scc1 L_nopub
  v_and_b32 v14, 127, v0
  v_lshlrev_b32 v15, 4, v14
  ds_read_b128 v[16:19], v15 offset:0
  ds_read_b128 v[20:23], v15 offset:2048
  ds_read_b128 v[24:27], v15 offset:4096
  ds_read_b128 v[28:31], v15 offset:6144
  ds_read_b128 v[32:35], v15 offset:8192
  ds_read_b128 v[36:39], v15 offset:10240
  ds_read_b128 v[40:43], v15 offset:12288
  v_lshrrev_b32 v14, 5, v14
  s_mov_b32 s74, 36352
  v_mad_u32_u24 v14, v14, s74, v15
  s_mul_i32 s74, s93, 147456
  s_lshl_b32 s76, s92, 9
  s_add_u32 s74, s74, s76
  s_add_u32 s74, s74, 1114112
  s_cmp_ge_u32 s66, 216
  s_cselect_b32 s74, 1073741824, s74
  s_waitcnt lgkmcnt(0)
  v_pk_add_f32 v[16:17], v[16:17], v[32:33]
  v_pk_add_f32 v[18:19], v[18:19], v[34:35]
  v_pk_add_f32 v[20:21], v[20:21], v[36:37]
  v_pk_add_f32 v[22:23], v[22:23], v[38:39]
  v_pk_add_f32 v[24:25], v[24:25], v[40:41]
  v_pk_add_f32 v[26:27], v[26:27], v[42:43]
  v_pk_add_f32 v[16:17], v[16:17], v[24:25]
  v_pk_add_f32 v[18:19], v[18:19], v[26:27]
  v_pk_add_f32 v[20:21], v[20:21], v[28:29]
  v_pk_add_f32 v[22:23], v[22:23], v[30:31]
  v_pk_add_f32 v[16:17], v[16:17], v[20:21]
  v_pk_add_f32 v[18:19], v[18:19], v[22:23]
  v_add_u32 v16, 0x80, v16
  v_add_u32 v18, 0x80, v18
  v_and_b32 v16, 0xffffff00, v16
  v_and_b32 v18, 0xffffff00, v18
  v_or_b32 v16, s70, v16
  v_or_b32 v18, s7, v18
  buffer_store_dwordx4 v[16:19], v14, s[32:35], s74 offen sc1 nt
L_nopub:
  s_waitcnt vmcnt(5)
  buffer_load_dwordx4 v[104:107], v8, s[8:11], s71 offen offset:1152 nt
  s_waitcnt vmcnt(5)
  buffer_load_dwordx4 v[108:111], v9, s[8:11], s71 offen offset:768 nt
  s_waitcnt vmcnt(5)
  s_add_u32 s71, s67, 16
  s_and_b32 s71, s71, 63
  s_mul_i32 s71, s71, 6144
  s_add_u32 s71, s71, s73
  buffer_load_dwordx4 v[112:115], v8, s[8:11], s71 offen offset:0 nt
  s_waitcnt vmcnt(5)
  s_sub_u32 m0, s43, 512
  s_nop 0
  buffer_load_dwordx4 v12, s[20:23], s40 offen offset:2560 sc1 lds
  s_waitcnt vmcnt(5)
  buffer_load_dwordx4 v[116:119], v8, s[8:11], s71 offen offset:384 nt
  s_cmp_lg_u32 s3, 3
  s_cbranch_scc1 L_noprd2
  v_lshlrev_b32 v62, 6, v1
  s_mov_b32 exec_hi, 0xff
  buffer_load_dword v63, v62, s[32:35], s90 offen sc1
  s_mov_b64 exec, -1
L_noprd2:
  s_waitcnt vmcnt(5)
  buffer_load_dwordx4 v[120:123], v9, s[8:11], s71 offen offset:0 nt
  s_waitcnt vmcnt(5)
  s_add_u32 m0, s43, 512
  s_nop 0
  buffer_load_dwordx4 v12, s[20:23], s64 offen offset:2560 sc1 lds
  s_waitcnt vmcnt(5)
  buffer_load_dwordx4 v[124:127], v8, s[8:11], s71 offen offset:768 nt
  s_waitcnt vmcnt(5)
  buffer_load_dwordx4 v[128:131], v8, s[8:11], s71 offen offset:1152 nt
  s_waitcnt vmcnt(5)
  buffer_load_dwordx4 v[132:135], v9, s[8:11], s71 offen offset:768 nt
  s_waitcnt vmcnt(5)
  s_add_u32 m0, s43, 4096
  s_nop 0
  buffer_load_dwordx4 v12, s[20:23], s41 offen offset:0 sc1 lds
  s_waitcnt vmcnt(5)
  s_add_u32 s71, s67, 24
  s_and_b32 s71, s71, 63
  s_mul_i32 s71, s71, 6144
  s_add_u32 s71, s71, s73
  buffer_load_dwordx4 v[136:139], v8, s[8:11], s71 offen offset:0 nt
  s_waitcnt vmcnt(5)
  buffer_load_dwordx4 v[140:143], v8, s[8:11], s71 offen offset:384 nt
  s_waitcnt vmcnt(5)
  s_add_u32 m0, s43, 5120
  s_nop 0
  buffer_load_dwordx4 v12, s[20:23], s65 offen offset:0 sc1 lds
  s_waitcnt vmcnt(5)
  buffer_load_dwordx4 v[144:147], v9, s[8:11], s71 offen offset:0 nt
  s_waitcnt vmcnt(5)
  buffer_load_dwordx4 v[148:151], v8, s[8:11], s71 offen offset:768 nt
  s_waitcnt vmcnt(5)
  s_add_u32 m0, s43, 5888
  s_nop 0
  buffer_load_dwordx4 v12, s[20:23], s40 offen offset:256 sc1 lds
  s_waitcnt vmcnt(5)
  buffer_load_dwordx4 v[152:155], v8, s[8:11], s71 offen offset:1152 nt
  s_waitcnt vmcnt(5)
  buffer_load_dwordx4 v[156:159], v9, s[8:11], s71 offen offset:768 nt
  s_waitcnt vmcnt(5)
  s_add_u32 s71, s67, 32
  s_and_b32 s71, s71, 63
  s_mul_i32 s71, s71, 6144
  s_add_u32 s71, s71, s73
  buffer_load_dwordx4 v[160:163], v8, s[8:11], s71 offen offset:0 nt
  s_waitcnt vmcnt(5)
  s_add_u32 m0, s43, 6912
  s_nop 0
  buffer_load_dwordx4 v12, s[20:23], s64 offen offset:256 sc1 lds
  s_waitcnt vmcnt(5)
  buffer_load_dwordx4 v[164:167], v8, s[8:11], s71 offen offset:384 nt
  s_waitcnt vmcnt(5)
  buffer_load_dwordx4 v[168:171], v9, s[8:11], s71 offen offset:0 nt
  s_waitcnt vmcnt(5)
  s_add_u32 m0, s43, 5376
  s_nop 0
  buffer_load_dwordx4 v12, s[20:23], s40 offen offset:2816 sc1 lds
  s_waitcnt vmcnt(5)
  buffer_load_dwordx4 v[172:175], v8, s[8:11], s71 offen offset:768 nt
  s_cmp_eq_u32 s3, 0
  s_cbranch_scc1 L_w0
  s_waitcnt vmcnt(5)
  buffer_load_dwordx4 v[176:179], v8, s[8:11], s71 offen offset:1152 nt
  s_waitcnt vmcnt(5)
  buffer_load_dwordx4 v[180:183], v9, s[8:11], s71 offen offset:768 nt
  s_waitcnt vmcnt(5)
  s_add_u32 m0, s43, 6400
  s_nop 0
  buffer_load_dwordx4 v12, s[20:23], s64 offen offset:2816 sc1 lds
  s_waitcnt vmcnt(5)
  s_add_u32 s71, s67, 40
  s_and_b32 s71, s71, 63
  s_mul_i32 s71, s71, 6144
  s_add_u32 s71, s71, s73
  buffer_load_dwordx4 v[184:187], v8, s[8:11], s71 offen offset:0 nt
  s_waitcnt vmcnt(5)
  buffer_load_dwordx4 v[188:191], v8, s[8:11], s71 offen offset:384 nt
  s_waitcnt vmcnt(5)
  s_add_u32 m0, s43, 9984
  s_nop 0
  buffer_load_dwordx4 v12, s[20:23], s41 offen offset:256 sc1 lds
  s_waitcnt vmcnt(5)
  buffer_load_dwordx4 v[192:195], v9, s[8:11], s71 offen offset:0 nt
  s_waitcnt vmcnt(5)
  buffer_load_dwordx4 v[196:199], v8, s[8:11], s71 offen offset:768 nt
  s_waitcnt vmcnt(5)
  s_add_u32 m0, s43, 11008
  s_nop 0
  buffer_load_dwordx4 v12, s[20:23], s65 offen offset:256 sc1 lds
  s_waitcnt vmcnt(5)
  buffer_load_dwordx4 v[200:203], v8, s[8:11], s71 offen offset:1152 nt
  s_waitcnt vmcnt(5)
  buffer_load_dwordx4 v[204:207], v9, s[8:11], s71 offen offset:768 nt
  s_waitcnt vmcnt(5)
  s_add_u32 s71, s67, 48
  s_and_b32 s71, s71, 63
  s_mul_i32 s71, s71, 6144
  s_add_u32 s71, s71, s73
  buffer_load_dwordx4 v[208:211], v8, s[8:11], s71 offen offset:0 nt
  s_waitcnt vmcnt(5)
  s_add_u32 m0, s43, 11776
  s_nop 0
  buffer_load_dwordx4 v12, s[20:23], s40 offen offset:512 sc1 lds
  s_waitcnt vmcnt(5)
  buffer_load_dwordx4 v[212:215], v8, s[8:11], s71 offen offset:384 nt
  s_waitcnt vmcnt(5)
  buffer_load_dwordx4 v[216:219], v9, s[8:11], s71 offen offset:0 nt
  s_waitcnt vmcnt(5)
  s_add_u32 m0, s43, 12800
  s_nop 0
  buffer_load_dwordx4 v12, s[20:23], s64 offen offset:512 sc1 lds
  s_waitcnt vmcnt(5)
  buffer_load_dwordx4 v[220:223], v8, s[8:11], s71 offen offset:768 nt
  s_waitcnt vmcnt(5)
  buffer_load_dwordx4 v[224:227], v8, s[8:11], s71 offen offset:1152 nt
  s_waitcnt vmcnt(5)
  buffer_load_dwordx4 v[228:231], v9, s[8:11], s71 offen offset:768 nt
  s_waitcnt vmcnt(5)
  s_add_u32 m0, s43, 11264
  s_nop 0
  buffer_load_dwordx4 v12, s[20:23], s40 offen offset:3072 sc1 lds
  s_waitcnt vmcnt(5)
  s_add_u32 s71, s67, 56
  s_and_b32 s71, s71, 63
  s_mul_i32 s71, s71, 6144
  s_add_u32 s71, s71, s73
  buffer_load_dwordx4 v[232:235], v8, s[8:11], s71 offen offset:0 nt
  s_waitcnt vmcnt(5)
  buffer_load_dwordx4 v[236:239], v8, s[8:11], s71 offen offset:384 nt
  s_waitcnt vmcnt(5)
  s_add_u32 m0, s43, 12288
  s_nop 0
  buffer_load_dwordx4 v12, s[20:23], s64 offen offset:3072 sc1 lds
  s_waitcnt vmcnt(5)
  buffer_load_dwordx4 v[240:243], v9, s[8:11], s71 offen offset:0 nt
  s_waitcnt vmcnt(5)
  buffer_load_dwordx4 v[244:247], v8, s[8:11], s71 offen offset:768 nt
  s_waitcnt vmcnt(5)
  s_add_u32 m0, s43, 15872
  s_nop 0
  buffer_load_dwordx4 v12, s[20:23], s41 offen offset:512 sc1 lds
  s_waitcnt vmcnt(5)
  buffer_load_dwordx4 v[248:251], v8, s[8:11], s71 offen offset:1152 nt
  s_waitcnt vmcnt(5)
  buffer_load_dwordx4 v[252:255], v9, s[8:11], s71 offen offset:768 nt
  s_branch L_join
L_w0:
  v_min_u32 v60, 59, v1
  v_lshlrev_b32 v60, 2, v60
  s_mul_i32 s74, s4, 192
  s_mul_i32 s76, s69, 24
  s_add_u32 s76, s76, 5952
  s_add_u32 s77, s76, 1512
  v_mov_b32 v61, s74
  v_mov_b32 v62, s76
  v_cmp_le_u32 vcc, 48, v1
  s_nop 1
  v_cndmask_b32 v61, v61, v62, vcc
  v_mov_b32 v62, s77
  v_cmp_le_u32 vcc, 54, v1
  s_nop 1
  v_cndmask_b32 v61, v61, v62, vcc
  v_add_u32 v60, v60, v61
  v_lshlrev_b32 v60, 2, v60
  s_mul_i32 s44, s5, 36864
  s_add_u32 s44, s44, 1114112
  s_add_u32 s45, s44, 147456
  s_add_u32 s46, s44, 294912
  s_mov_b32 s75, 524288
  buffer_load_dwordx4 v[16:19], v60, s[32:35], s44 offen sc1
  buffer_load_dwordx4 v[20:23], v60, s[32:35], s45 offen sc1
  buffer_load_dwordx4 v[24:27], v60, s[32:35], s46 offen sc1
  buffer_load_dwordx4 v[176:179], v8, s[8:11], s71 offen offset:1152 nt
  buffer_load_dwordx4 v[180:183], v9, s[8:11], s71 offen offset:768 nt
  s_add_u32 m0, s43, 6400
  s_nop 0
  buffer_load_dwordx4 v12, s[20:23], s64 offen offset:2816 sc1 lds
  s_waitcnt vmcnt(5)
  s_add_u32 s71, s67, 40
  s_and_b32 s71, s71, 63
  s_mul_i32 s71, s71, 6144
  s_add_u32 s71, s71, s73
  buffer_load_dwordx4 v[184:187], v8, s[8:11], s71 offen offset:0 nt
  s_waitcnt vmcnt(5)
  buffer_load_dwordx4 v[188:191], v8, s[8:11], s71 offen offset:384 nt
  s_waitcnt vmcnt(5)
L_spin1:
  v_xor_b32 v16, s70, v16
  v_xor_b32 v18, s7, v18
  v_xor_b32 v20, s70, v20
  v_xor_b32 v22, s7, v22
  v_xor_b32 v24, s70, v24
  v_xor_b32 v26, s7, v26
  v_or3_b32 v14, v16, v18, v20
  v_or3_b32 v15, v22, v24, v26
  v_or_b32 v14, v14, v15
  v_and_b32 v14, 0xff, v14
  v_cmp_ne_u32 vcc, 0, v14
  s_nop 1
  s_cbranch_vccz L_ok1
  s_sub_u32 s75, s75, 1
  s_cbranch_scc1 L_ok1
  s_sleep 8
  buffer_load_dwordx4 v[16:19], v60, s[32:35], s44 offen sc1
  buffer_load_dwordx4 v[20:23], v60, s[32:35], s45 offen sc1
  buffer_load_dwordx4 v[24:27], v60, s[32:35], s46 offen sc1
  s_waitcnt vmcnt(0)
  s_nop 11
  s_branch L_spin1
L_ok1:
  v_pk_add_f32 v[16:17], v[16:17], v[20:21]
  v_pk_add_f32 v[18:19], v[18:19], v[22:23]
  v_pk_add_f32 v[16:17], v[16:17], v[24:25]
  v_pk_add_f32 v[18:19], v[18:19], v[26:27]
  v_cvt_pk_bf16_f32 v16, v16, v17
  v_cvt_pk_bf16_f32 v17, v18, v19
  v_lshlrev_b32 v14, 3, v1
  ds_write_b64 v14, v[16:17] offset:15360
  v_min_u32 v14, 23, v1
  v_lshlrev_b32 v14, 1, v14
  s_waitcnt lgkmcnt(0)
  ds_read_u16 v20, v14 offset:15744
  ds_read_u16 v21, v14 offset:15792
  s_waitcnt lgkmcnt(0)
  v_lshlrev_b32 v20, 16, v20
  v_lshlrev_b32 v21, 16, v21
  v_mul_f32 v22, v20, v20
  v_mul_f32 v22, 0x3d372713, v22
  v_fma_f32 v22, v22, v20, v20
  v_mul_f32 v22, 0xc0135761, v22
  v_exp_f32 v22, v22
  s_nop 0
  v_add_f32 v22, 1.0, v22
  v_rcp_f32 v22, v22
  s_nop 0
  v_mul_f32 v22, v22, v20
  v_cvt_pk_bf16_f32 v22, v22, v22
  v_and_b32 v22, 0xffff0000, v22
  v_mul_f32 v22, v22, v21
  v_cvt_pk_bf16_f32 v22, v22, v22
  v_cmp_gt_u32 vcc, 24, v1
  s_nop 1
  v_cndmask_b32 v22, 0, v22, vcc
  v_min_u32 v14, 31, v1
  v_lshlrev_b32 v14, 2, v14
  ds_write_b32 v14, v22 offset:15872
  v_mov_b32 v14, 16000
  v_mov_b32 v15, 1
  s_waitcnt lgkmcnt(0)
  ds_write_b32 v14, v15 offset:4
  s_waitcnt vmcnt(5)
  s_add_u32 m0, s43, 9984
  s_nop 0
  buffer_load_dwordx4 v12, s[20:23], s41 offen offset:256 sc1 lds
  s_waitcnt vmcnt(5)
  buffer_load_dwordx4 v[192:195], v9, s[8:11], s71 offen offset:0 nt
  s_waitcnt vmcnt(5)
  buffer_load_dwordx4 v[196:199], v8, s[8:11], s71 offen offset:768 nt
  s_waitcnt vmcnt(5)
  s_add_u32 m0, s43, 11008
  s_nop 0
  buffer_load_dwordx4 v12, s[20:23], s65 offen offset:256 sc1 lds
  s_waitcnt vmcnt(5)
  buffer_load_dwordx4 v[200:203], v8, s[8:11], s71 offen offset:1152 nt
  s_waitcnt vmcnt(5)
  buffer_load_dwordx4 v[204:207], v9, s[8:11], s71 offen offset:768 nt
  s_waitcnt vmcnt(5)
  s_add_u32 s71, s67, 48
  s_and_b32 s71, s71, 63
  s_mul_i32 s71, s71, 6144
  s_add_u32 s71, s71, s73
  buffer_load_dwordx4 v[208:211], v8, s[8:11], s71 offen offset:0 nt
  s_waitcnt vmcnt(5)
  s_add_u32 m0, s43, 11776
  s_nop 0
  buffer_load_dwordx4 v12, s[20:23], s40 offen offset:512 sc1 lds
  s_waitcnt vmcnt(5)
  buffer_load_dwordx4 v[212:215], v8, s[8:11], s71 offen offset:384 nt
  s_waitcnt vmcnt(5)
  buffer_load_dwordx4 v[216:219], v9, s[8:11], s71 offen offset:0 nt
  s_waitcnt vmcnt(5)
  s_add_u32 m0, s43, 12800
  s_nop 0
  buffer_load_dwordx4 v12, s[20:23], s64 offen offset:512 sc1 lds
  s_waitcnt vmcnt(5)
  buffer_load_dwordx4 v[220:223], v8, s[8:11], s71 offen offset:768 nt
  s_waitcnt vmcnt(5)
  buffer_load_dwordx4 v[224:227], v8, s[8:11], s71 offen offset:1152 nt
  s_waitcnt vmcnt(5)
  buffer_load_dwordx4 v[228:231], v9, s[8:11], s71 offen offset:768 nt
  s_waitcnt vmcnt(5)
  s_add_u32 m0, s43, 11264
  s_nop 0
  buffer_load_dwordx4 v12, s[20:23], s40 offen offset:3072 sc1 lds
  s_waitcnt vmcnt(5)
  s_add_u32 s71, s67, 56
  s_and_b32 s71, s71, 63
  s_mul_i32 s71, s71, 6144
  s_add_u32 s71, s71, s73
  buffer_load_dwordx4 v[232:235], v8, s[8:11], s71 offen offset:0 nt
  s_waitcnt vmcnt(5)
  buffer_load_dwordx4 v[236:239], v8, s[8:11], s71 offen offset:384 nt
  s_waitcnt vmcnt(5)
  s_add_u32 m0, s43, 12288
  s_nop 0
  buffer_load_dwordx4 v12, s[20:23], s64 offen offset:3072 sc1 lds
  s_waitcnt vmcnt(5)
  buffer_load_dwordx4 v[240:243], v9, s[8:11], s71 offen offset:0 nt
  s_waitcnt vmcnt(5)
  buffer_load_dwordx4 v[244:247], v8, s[8:11], s71 offen offset:768 nt
  s_waitcnt vmcnt(5)
  s_add_u32 m0, s43, 15872
  s_nop 0
  buffer_load_dwordx4 v12, s[20:23], s41 offen offset:512 sc1 lds
  s_waitcnt vmcnt(5)
  buffer_load_dwordx4 v[248:251], v8, s[8:11], s71 offen offset:1152 nt
  s_waitcnt vmcnt(5)
  buffer_load_dwordx4 v[252:255], v9, s[8:11], s71 offen offset:768 nt
L_join:
  v_mov_b32 v14, 16000
  s_mov_b32 s75, 16777216
L_spinq:
  ds_read_b32 v15, v14 offset:4
  s_waitcnt lgkmcnt(0)
  v_readfirstlane_b32 s74, v15
  s_nop 1
  s_cmp_lg_u32 s74, 0
  s_cbranch_scc1 L_okq
  s_sub_u32 s75, s75, 1
  s_cbranch_scc1 L_okq
  s_sleep 1
  s_nop 11
  s_branch L_spinq
L_okq:
  v_and_b32 v14, 3, v2
  v_lshl_add_u32 v15, v3, 2, v14
  v_lshlrev_b32 v15, 4, v15
  ds_read_b128 v[56:59], v15 offset:15360
  v_and_b32 v15, 0x70, v15
  ds_read_b128 v[60:63], v15 offset:15616
  s_mov_b32 s44, 0xf000f
  s_mov_b32 s45, 0xf000f
  s_mov_b32 s46, 0xf000f0
  s_mov_b32 s47, 0xf000f0
  s_mov_b32 s48, 0xf000f00
  s_mov_b32 s49, 0xf000f00
  s_mov_b32 s50, 0xf000f000
  s_mov_b32 s51, 0xf000f000
  s_mov_b32 s52, 0xf000f
  s_mov_b32 s53, 0xf000f0
  s_mov_b32 s54, 0xf000f00
  s_mov_b32 s55, 0xf000f000
  s_waitcnt lgkmcnt(0)
  v_cndmask_b32 v32, 0, v56, s[44:45]
  v_cndmask_b32 v33, 0, v57, s[44:45]
  v_cndmask_b32 v34, 0, v58, s[44:45]
  v_cndmask_b32 v35, 0, v59, s[44:45]
  v_cndmask_b32 v36, 0, v56, s[46:47]
  v_cndmask_b32 v37, 0, v57, s[46:47]
  v_cndmask_b32 v38, 0, v58, s[46:47]
  v_cndmask_b32 v39, 0, v59, s[46:47]
  v_cndmask_b32 v40, 0, v56, s[48:49]
  v_cndmask_b32 v41, 0, v57, s[48:49]
  v_cndmask_b32 v42, 0, v58, s[48:49]
  v_cndmask_b32 v43, 0, v59, s[48:49]
  v_cndmask_b32 v44, 0, v56, s[50:51]
  v_cndmask_b32 v45, 0, v57, s[50:51]
  v_cndmask_b32 v46, 0, v58, s[50:51]
  v_cndmask_b32 v47, 0, v59, s[50:51]
  v_cndmask_b32 v48, 0, v60, s[52:53]
  v_cndmask_b32 v49, 0, v61, s[52:53]
  v_cndmask_b32 v50, 0, v62, s[52:53]
  v_cndmask_b32 v51, 0, v63, s[52:53]
  v_cndmask_b32 v52, 0, v60, s[54:55]
  v_cndmask_b32 v53, 0, v61, s[54:55]
  v_cndmask_b32 v54, 0, v62, s[54:55]
  v_cndmask_b32 v55, 0, v63, s[54:55]
  s_waitcnt vmcnt(6)
  v_mfma_f32_16x16x32_bf16 v[24:27], v[32:35], v[64:67], 0
  v_mfma_f32_16x16x32_bf16 v[24:27], v[36:39], v[68:71], v[24:27]
  v_mfma_f32_16x16x32_bf16 v[24:27], v[48:51], v[72:75], v[24:27]
  v_mfma_f32_16x16x32_bf16 v[24:27], v[40:43], v[76:79], v[24:27]
  v_mfma_f32_16x16x32_bf16 v[24:27], v[44:47], v[80:83], v[24:27]
  v_mfma_f32_16x16x32_bf16 v[24:27], v[52:55], v[84:87], v[24:27]
  s_waitcnt vmcnt(4)
  s_add_u32 s71, s67, 0
  s_and_b32 s71, s71, 63
  s_mul_i32 s71, s71, 6144
  s_add_u32 s71, s71, s73
  s_add_u32 s72, s71, 3072
  buffer_load_dwordx4 v[64:67], v10, s[12:15], s71 offen offset:0 nt
  buffer_load_dwordx4 v[68:71], v10, s[12:15], s72 offen offset:0 nt
  v_mfma_f32_16x16x32_bf16 v[28:31], v[32:35], v[88:91], 0
  v_mfma_f32_16x16x32_bf16 v[28:31], v[36:39], v[92:95], v[28:31]
  v_mfma_f32_16x16x32_bf16 v[28:31], v[48:51], v[96:99], v[28:31]
  v_mfma_f32_16x16x32_bf16 v[28:31], v[40:43], v[100:103], v[28:31]
  v_mfma_f32_16x16x32_bf16 v[28:31], v[44:47], v[104:107], v[28:31]
  v_mfma_f32_16x16x32_bf16 v[28:31], v[52:55], v[108:111], v[28:31]
  v_mov_b32_dpp v16, v24 quad_perm:[0,0,0,0] row_mask:0xf bank_mask:0xf
  v_mov_b32_dpp v14, v26 quad_perm:[2,2,2,2] row_mask:0xf bank_mask:0xf
  s_nop 0
  v_add_f32_dpp v16, v25, v16 quad_perm:[1,1,1,1] row_mask:0xf bank_mask:0xf
  v_add_f32_dpp v14, v27, v14 quad_perm:[3,3,3,3] row_mask:0xf bank_mask:0xf
  v_add_f32 v16, v16, v14
  v_cvt_pk_bf16_f32 v16, v16, v16
  v_and_b32 v16, 0xffff0000, v16
  v_mul_f32 v16, 0x3d93cd3a, v16
  v_cvt_pk_bf16_f32 v16, v16, v16
  v_and_b32 v16, 0xffff0000, v16
  v_mfma_f32_16x16x32_bf16 v[24:27], v[32:35], v[112:115], 0
  v_mfma_f32_16x16x32_bf16 v[24:27], v[36:39], v[116:119], v[24:27]
  v_mfma_f32_16x16x32_bf16 v[24:27], v[48:51], v[120:123], v[24:27]
  v_mfma_f32_16x16x32_bf16 v[24:27], v[40:43], v[124:127], v[24:27]
  v_mfma_f32_16x16x32_bf16 v[24:27], v[44:47], v[128:131], v[24:27]
  v_mfma_f32_16x16x32_bf16 v[24:27], v[52:55], v[132:135], v[24:27]
  s_waitcnt vmcnt(5)
  buffer_load_dwordx4 v[72:75], v11, s[12:15], s71 offen offset:0 nt
  v_mov_b32_dpp v17, v28 quad_perm:[0,0,0,0] row_mask:0xf bank_mask:0xf
  v_mov_b32_dpp v14, v30 quad_perm:[2,2,2,2] row_mask:0xf bank_mask:0xf
  s_nop 0
  v_add_f32_dpp v17, v29, v17 quad_perm:[1,1,1,1] row_mask:0xf bank_mask:0xf
  v_add_f32_dpp v14, v31, v14 quad_perm:[3,3,3,3] row_mask:0xf bank_mask:0xf
  v_add_f32 v17, v17, v14
  v_cvt_pk_bf16_f32 v17, v17, v17
  v_and_b32 v17, 0xffff0000, v17
  v_mul_f32 v17, 0x3d93cd3a, v17
  v_cvt_pk_bf16_f32 v17, v17, v17
  v_and_b32 v17, 0xffff0000, v17
  v_mfma_f32_16x16x32_bf16 v[28:31], v[32:35], v[136:139], 0
  v_mfma_f32_16x16x32_bf16 v[28:31], v[36:39], v[140:143], v[28:31]
  v_mfma_f32_16x16x32_bf16 v[28:31], v[48:51], v[144:147], v[28:31]
  v_mfma_f32_16x16x32_bf16 v[28:31], v[40:43], v[148:151], v[28:31]
  v_mfma_f32_16x16x32_bf16 v[28:31], v[44:47], v[152:155], v[28:31]
  v_mfma_f32_16x16x32_bf16 v[28:31], v[52:55], v[156:159], v[28:31]
  v_mov_b32_dpp v18, v24 quad_perm:[0,0,0,0] row_mask:0xf bank_mask:0xf
  v_mov_b32_dpp v14, v26 quad_perm:[2,2,2,2] row_mask:0xf bank_mask:0xf
  s_nop 0
  v_add_f32_dpp v18, v25, v18 quad_perm:[1,1,1,1] row_mask:0xf bank_mask:0xf
  v_add_f32_dpp v14, v27, v14 quad_perm:[3,3,3,3] row_mask:0xf bank_mask:0xf
  v_add_f32 v18, v18, v14
  v_cvt_pk_bf16_f32 v18, v18, v18
  v_and_b32 v18, 0xffff0000, v18
  v_mul_f32 v18, 0x3d93cd3a, v18
  v_cvt_pk_bf16_f32 v18, v18, v18
  v_and_b32 v18, 0xffff0000, v18
  v_mfma_f32_16x16x32_bf16 v[24:27], v[32:35], v[160:163], 0
  v_mfma_f32_16x16x32_bf16 v[24:27], v[36:39], v[164:167], v[24:27]
  v_mfma_f32_16x16x32_bf16 v[24:27], v[48:51], v[168:171], v[24:27]
  v_mfma_f32_16x16x32_bf16 v[24:27], v[40:43], v[172:175], v[24:27]
  v_mfma_f32_16x16x32_bf16 v[24:27], v[44:47], v[176:179], v[24:27]
  v_mfma_f32_16x16x32_bf16 v[24:27], v[52:55], v[180:183], v[24:27]
  s_waitcnt vmcnt(4)
  buffer_load_dwordx4 v[76:79], v10, s[12:15], s71 offen offset:1536 nt
  buffer_load_dwordx4 v[80:83], v10, s[12:15], s72 offen offset:1536 nt
  v_mov_b32_dpp v19, v28 quad_perm:[0,0,0,0] row_mask:0xf bank_mask:0xf
  v_mov_b32_dpp v14, v30 quad_perm:[2,2,2,2] row_mask:0xf bank_mask:0xf
  s_nop 0
  v_add_f32_dpp v19, v29, v19 quad_perm:[1,1,1,1] row_mask:0xf bank_mask:0xf
  v_add_f32_dpp v14, v31, v14 quad_perm:[3,3,3,3] row_mask:0xf bank_mask:0xf
  v_add_f32 v19, v19, v14
  v_cvt_pk_bf16_f32 v19, v19, v19
  v_and_b32 v19, 0xffff0000, v19
  v_mul_f32 v19, 0x3d93cd3a, v19
  v_cvt_pk_bf16_f32 v19, v19, v19
  v_and_b32 v19, 0xffff0000, v19
  v_mfma_f32_16x16x32_bf16 v[28:31], v[32:35], v[184:187], 0
  v_mfma_f32_16x16x32_bf16 v[28:31], v[36:39], v[188:191], v[28:31]
  v_mfma_f32_16x16x32_bf16 v[28:31], v[48:51], v[192:195], v[28:31]
  v_mfma_f32_16x16x32_bf16 v[28:31], v[40:43], v[196:199], v[28:31]
  v_mfma_f32_16x16x32_bf16 v[28:31], v[44:47], v[200:203], v[28:31]
  v_mfma_f32_16x16x32_bf16 v[28:31], v[52:55], v[204:207], v[28:31]
  v_mov_b32_dpp v20, v24 quad_perm:[0,0,0,0] row_mask:0xf bank_mask:0xf
  v_mov_b32_dpp v14, v26 quad_perm:[2,2,2,2] row_mask:0xf bank_mask:0xf
  s_nop 0
  v_add_f32_dpp v20, v25, v20 quad_perm:[1,1,1,1] row_mask:0xf bank_mask:0xf
  v_add_f32_dpp v14, v27, v14 quad_perm:[3,3,3,3] row_mask:0xf bank_mask:0xf
  v_add_f32 v20, v20, v14
  v_cvt_pk_bf16_f32 v20, v20, v20
  v_and_b32 v20, 0xffff0000, v20
  v_mul_f32 v20, 0x3d93cd3a, v20
  v_cvt_pk_bf16_f32 v20, v20, v20
  v_and_b32 v20, 0xffff0000, v20
  v_mfma_f32_16x16x32_bf16 v[24:27], v[32:35], v[208:211], 0
  v_mfma_f32_16x16x32_bf16 v[24:27], v[36:39], v[212:215], v[24:27]
  v_mfma_f32_16x16x32_bf16 v[24:27], v[48:51], v[216:219], v[24:27]
  v_mfma_f32_16x16x32_bf16 v[24:27], v[40:43], v[220:223], v[24:27]
  v_mfma_f32_16x16x32_bf16 v[24:27], v[44:47], v[224:227], v[24:27]
  v_mfma_f32_16x16x32_bf16 v[24:27], v[52:55], v[228:231], v[24:27]
  s_waitcnt vmcnt(5)
  buffer_load_dwordx4 v[112:115], v13, s[24:27], s42 offen offset:0 sc1
  v_mov_b32_dpp v21, v28 quad_perm:[0,0,0,0] row_mask:0xf bank_mask:0xf
  v_mov_b32_dpp v14, v30 quad_perm:[2,2,2,2] row_mask:0xf bank_mask:0xf
  s_nop 0
  v_add_f32_dpp v21, v29, v21 quad_perm:[1,1,1,1] row_mask:0xf bank_mask:0xf
  v_add_f32_dpp v14, v31, v14 quad_perm:[3,3,3,3] row_mask:0xf bank_mask:0xf
  v_add_f32 v21, v21, v14
  v_cvt_pk_bf16_f32 v21, v21, v21
  v_and_b32 v21, 0xffff0000, v21
  v_mul_f32 v21, 0x3d93cd3a, v21
  v_cvt_pk_bf16_f32 v21, v21, v21
  v_and_b32 v21, 0xffff0000, v21
  v_mfma_f32_16x16x32_bf16 v[28:31], v[32:35], v[232:235], 0
  v_mfma_f32_16x16x32_bf16 v[28:31], v[36:39], v[236:239], v[28:31]
  v_mfma_f32_16x16x32_bf16 v[28:31], v[48:51], v[240:243], v[28:31]
  v_mfma_f32_16x16x32_bf16 v[28:31], v[40:43], v[244:247], v[28:31]
  v_mfma_f32_16x16x32_bf16 v[28:31], v[44:47], v[248:251], v[28:31]
  v_mfma_f32_16x16x32_bf16 v[28:31], v[52:55], v[252:255], v[28:31]
  v_mov_b32_dpp v22, v24 quad_perm:[0,0,0,0] row_mask:0xf bank_mask:0xf
  v_mov_b32_dpp v14, v26 quad_perm:[2,2,2,2] row_mask:0xf bank_mask:0xf
  s_nop 0
  v_add_f32_dpp v22, v25, v22 quad_perm:[1,1,1,1] row_mask:0xf bank_mask:0xf
  v_add_f32_dpp v14, v27, v14 quad_perm:[3,3,3,3] row_mask:0xf bank_mask:0xf
  v_add_f32 v22, v22, v14
  v_cvt_pk_bf16_f32 v22, v22, v22
  v_and_b32 v22, 0xffff0000, v22
  v_mul_f32 v22, 0x3d93cd3a, v22
  v_cvt_pk_bf16_f32 v22, v22, v22
  v_and_b32 v22, 0xffff0000, v22
  v_mov_b32_dpp v23, v28 quad_perm:[0,0,0,0] row_mask:0xf bank_mask:0xf
  v_mov_b32_dpp v14, v30 quad_perm:[2,2,2,2] row_mask:0xf bank_mask:0xf
  s_nop 0
  v_add_f32_dpp v23, v29, v23 quad_perm:[1,1,1,1] row_mask:0xf bank_mask:0xf
  v_add_f32_dpp v14, v31, v14 quad_perm:[3,3,3,3] row_mask:0xf bank_mask:0xf
  v_add_f32 v23, v23, v14
  v_cvt_pk_bf16_f32 v23, v23, v23
  v_and_b32 v23, 0xffff0000, v23
  v_mul_f32 v23, 0x3d93cd3a, v23
  v_cvt_pk_bf16_f32 v23, v23, v23
  v_and_b32 v23, 0xffff0000, v23
  s_waitcnt vmcnt(8)
  v_lshlrev_b32 v14, 4, v1
  v_add_u32 v14, s43, v14
  ds_read_b128 v[132:135], v14 offset:0
  ds_read_b128 v[136:139], v14 offset:1024
  ds_read_b128 v[140:143], v14 offset:2048
  ds_read_b128 v[144:147], v14 offset:3072
  ds_read_b128 v[148:151], v14 offset:4096
  ds_read_b128 v[152:155], v14 offset:5120
  ds_read_b128 v[156:159], v14 offset:6144
  ds_read_b128 v[160:163], v14 offset:7168
  ds_read_b128 v[164:167], v14 offset:8192
  ds_read_b128 v[168:171], v14 offset:9216
  ds_read_b128 v[172:175], v14 offset:10240
  ds_read_b128 v[176:179], v14 offset:11264
  ds_read_b128 v[180:183], v14 offset:12288
  ds_read_b128 v[184:187], v14 offset:13312
  ds_read_b128 v[188:191], v14 offset:14336
  ds_read_b128 v[192:195], v14 offset:15360
  ds_read_b128 v[196:199], v14 offset:16384
  v_max3_f32 v28, v16, v17, v18
  v_max3_f32 v15, v19, v20, v21
  v_max3_f32 v28, v28, v22, v23
  v_max_f32 v28, v28, v15
  s_nop 1
  v_max_f32_dpp v28, v28, v28 row_ror:4 row_mask:0xf bank_mask:0xf
  s_nop 1
  v_max_f32_dpp v28, v28, v28 row_ror:8 row_mask:0xf bank_mask:0xf
  v_mov_b32 v15, v28
  s_nop 1
  v_permlane16_swap_b32 v28, v15
  v_max_f32 v28, v28, v15
  v_mov_b32 v15, v28
  s_nop 1
  v_permlane32_swap_b32 v28, v15
  v_max_f32 v28, v28, v15
  v_sub_f32 v16, v16, v28
  v_sub_f32 v17, v17, v28
  v_sub_f32 v18, v18, v28
  v_sub_f32 v19, v19, v28
  v_sub_f32 v20, v20, v28
  v_sub_f32 v21, v21, v28
  v_sub_f32 v22, v22, v28
  v_sub_f32 v23, v23, v28
  v_mul_f32 v16, 0x3fb8aa3b, v16
  v_mul_f32 v17, 0x3fb8aa3b, v17
  v_mul_f32 v18, 0x3fb8aa3b, v18
  v_mul_f32 v19, 0x3fb8aa3b, v19
  v_mul_f32 v20, 0x3fb8aa3b, v20
  v_mul_f32 v21, 0x3fb8aa3b, v21
  v_mul_f32 v22, 0x3fb8aa3b, v22
  v_mul_f32 v23, 0x3fb8aa3b, v23
  v_exp_f32 v16, v16
  v_exp_f32 v17, v17
  v_exp_f32 v18, v18
  v_exp_f32 v19, v19
  v_exp_f32 v20, v20
  v_exp_f32 v21, v21
  v_exp_f32 v22, v22
  v_exp_f32 v23, v23
  v_add_f32 v30, v16, v17
  v_add_f32 v24, v18, v19
  v_add_f32 v25, v20, v21
  v_add_f32 v26, v22, v23
  v_add_f32 v30, v30, v24
  v_add_f32 v25, v25, v26
  v_add_f32 v30, v30, v25
  s_nop 1
  v_add_f32_dpp v30, v30, v30 row_ror:4 row_mask:0xf bank_mask:0xf
  s_nop 1
  v_add_f32_dpp v30, v30, v30 row_ror:8 row_mask:0xf bank_mask:0xf
  v_mov_b32 v24, v30
  s_nop 1
  v_permlane16_swap_b32 v30, v24
  v_add_f32 v30, v30, v24
  v_mov_b32 v24, v30
  s_nop 1
  v_permlane32_swap_b32 v30, v24
  v_add_f32 v30, v30, v24
  v_cvt_pk_bf16_f32 v16, v16, v16
  v_cvt_pk_bf16_f32 v17, v17, v17
  v_cvt_pk_bf16_f32 v18, v18, v18
  v_cvt_pk_bf16_f32 v19, v19, v19
  v_cvt_pk_bf16_f32 v20, v20, v20
  v_cvt_pk_bf16_f32 v21, v21, v21
  v_readfirstlane_b32 s88, v28
  v_mov_b32 v29, v30
  s_lshl_b32 s74, s3, 3
  v_mov_b32 v24, s74
  v_mov_b32 v25, 0
  v_mov_b32 v26, 1
  s_mov_b64 exec, 1
  ds_write_b64 v24, v[28:29] offset:16064
  ds_add_rtn_u32 v27, v25, v26 offset:16000
  s_mov_b64 exec, -1
  s_waitcnt lgkmcnt(0)
  v_readfirstlane_b32 s74, v27
  s_nop 1
  s_cmp_lg_u32 s74, 7
  s_cbranch_scc1 L_nostat
  v_and_b32 v24, 7, v1
  v_lshlrev_b32 v25, 3, v24
  ds_read_b64 v[26:27], v25 offset:16064
  v_lshlrev_b32 v24, 4, v24
  s_waitcnt lgkmcnt(0)
  v_mov_b32 v28, v26
  s_nop 1
  v_max_f32_dpp v28, v28, v28 row_ror:4 row_mask:0xf bank_mask:0xf
  s_nop 1
  v_max_f32_dpp v28, v28, v28 row_ror:2 row_mask:0xf bank_mask:0xf
  s_nop 1
  v_max_f32_dpp v28, v28, v28 row_ror:1 row_mask:0xf bank_mask:0xf
  v_sub_f32 v26, v26, v28
  v_mul_f32 v26, 0x3fb8aa3b, v26
  v_exp_f32 v26, v26
  s_nop 0
  v_mul_f32 v30, v26, v27
  s_nop 1
  v_add_f32_dpp v30, v30, v30 row_ror:4 row_mask:0xf bank_mask:0xf
  s_nop 1
  v_add_f32_dpp v30, v30, v30 row_ror:2 row_mask:0xf bank_mask:0xf
  s_nop 1
  v_add_f32_dpp v30, v30, v30 row_ror:1 row_mask:0xf bank_mask:0xf
  v_mov_b32 v29, s100
  v_mov_b32 v31, s101
  s_mov_b64 exec, 255
  buffer_store_dwordx4 v[28:31], v24, s[32:35], s89 offen sc1 nt
  s_mov_b64 exec, -1
L_nostat:
  s_mul_i32 s74, s3, 12
  v_lshlrev_b32 v24, 2, v3
  v_add_u32 v24, s74, v24
  v_mov_b32 v25, 124
  v_cmp_eq_u32 vcc, 3, v3
  s_nop 1
  v_cndmask_b32 v24, v24, v25, vcc
  ds_read_b32 v14, v24 offset:15872
  s_waitcnt lgkmcnt(0)
  v_mov_b32 v15, v16
  s_nop 1
  v_mov_b32_dpp v15, v16 row_shr:4 row_mask:0xf bank_mask:0xa
  v_and_b32 v24, v15, v4
  v_and_b32 v25, v15, v5
  v_and_b32 v26, v15, v6
  v_and_b32 v27, v15, v7
  s_waitcnt vmcnt(5)
  s_nop 0
  v_mfma_f32_16x16x32_bf16 v[32:35], v[24:27], v[64:67], 0
  buffer_load_dwordx4 v[84:87], v11, s[12:15], s71 offen offset:1536 nt
  s_waitcnt vmcnt(5)
  v_mfma_f32_16x16x32_bf16 v[36:39], v[24:27], v[68:71], 0
  buffer_load_dwordx4 v[116:119], v13, s[24:27], s42 offen offset:256 sc1
  s_waitcnt vmcnt(5)
  v_mfma_f32_16x16x32_bf16 v[40:43], v[24:27], v[72:75], 0
  s_add_u32 s71, s67, 8
  s_and_b32 s71, s71, 63
  s_mul_i32 s71, s71, 6144
  s_add_u32 s71, s71, s73
  s_add_u32 s72, s71, 3072
  buffer_load_dwordx4 v[88:91], v10, s[12:15], s71 offen offset:0 nt
  v_mov_b32 v15, v16
  s_nop 1
  v_mov_b32_dpp v15, v16 row_shl:4 row_mask:0xf bank_mask:0x5
  v_and_b32 v28, v15, v4
  v_and_b32 v29, v15, v5
  v_and_b32 v30, v15, v6
  v_and_b32 v31, v15, v7
  s_waitcnt vmcnt(5)
  s_nop 0
  v_mfma_f32_16x16x32_bf16 v[32:35], v[28:31], v[76:79], v[32:35]
  buffer_load_dwordx4 v[120:123], v13, s[24:27], s42 offen offset:512 sc1
  s_waitcnt vmcnt(5)
  v_mfma_f32_16x16x32_bf16 v[36:39], v[28:31], v[80:83], v[36:39]
  buffer_load_dwordx4 v[92:95], v10, s[12:15], s72 offen offset:0 nt
  s_waitcnt vmcnt(4)
  v_mfma_f32_16x16x32_bf16 v[40:43], v[28:31], v[84:87], v[40:43]
  buffer_load_dwordx4 v[124:127], v13, s[24:27], s42 offen offset:768 sc1
  buffer_load_dwordx4 v[96:99], v11, s[12:15], s71 offen offset:0 nt
  v_mov_b32 v15, v17
  s_nop 1
  v_mov_b32_dpp v15, v17 row_shr:4 row_mask:0xf bank_mask:0xa
  v_and_b32 v24, v15, v4
  v_and_b32 v25, v15, v5
  v_and_b32 v26, v15, v6
  v_and_b32 v27, v15, v7
  s_waitcnt vmcnt(4)
  s_nop 0
  v_mfma_f32_16x16x32_bf16 v[32:35], v[24:27], v[88:91], v[32:35]
  buffer_load_dwordx4 v[128:131], v13, s[24:27], s42 offen offset:1024 sc1
  buffer_load_dwordx4 v[100:103], v10, s[12:15], s71 offen offset:1536 nt
  s_waitcnt vmcnt(4)
  v_mfma_f32_16x16x32_bf16 v[36:39], v[24:27], v[92:95], v[36:39]
  buffer_load_dwordx4 v[104:107], v10, s[12:15], s72 offen offset:1536 nt
  buffer_load_dwordx4 v[108:111], v11, s[12:15], s71 offen offset:1536 nt
  s_waitcnt vmcnt(4)
  v_mfma_f32_16x16x32_bf16 v[40:43], v[24:27], v[96:99], v[40:43]
  s_add_u32 s71, s67, 16
  s_and_b32 s71, s71, 63
  s_mul_i32 s71, s71, 6144
  s_add_u32 s71, s71, s73
  s_add_u32 s72, s71, 3072
  buffer_load_dwordx4 v[64:67], v10, s[12:15], s71 offen offset:0 nt
  buffer_load_dwordx4 v[68:71], v10, s[12:15], s72 offen offset:0 nt
  v_mov_b32 v15, v17
  s_nop 1
  v_mov_b32_dpp v15, v17 row_shl:4 row_mask:0xf bank_mask:0x5
  v_and_b32 v28, v15, v4
  v_and_b32 v29, v15, v5
  v_and_b32 v30, v15, v6
  v_and_b32 v31, v15, v7
  s_waitcnt vmcnt(4)
  s_nop 0
  v_mfma_f32_16x16x32_bf16 v[32:35], v[28:31], v[100:103], v[32:35]
  buffer_load_dwordx4 v[200:203], v12, s[20:23], s65 offen offset:512 sc1
  buffer_load_dwordx4 v[72:75], v11, s[12:15], s71 offen offset:0 nt
  s_waitcnt vmcnt(5)
  v_mfma_f32_16x16x32_bf16 v[36:39], v[28:31], v[104:107], v[36:39]
  buffer_load_dwordx4 v[76:79], v10, s[12:15], s71 offen offset:1536 nt
  s_waitcnt vmcnt(5)
  v_mfma_f32_16x16x32_bf16 v[40:43], v[28:31], v[108:111], v[40:43]
  buffer_load_dwordx4 v[204:207], v12, s[20:23], s40 offen offset:768 sc1
  v_mov_b32 v15, v18
  s_nop 1
  v_mov_b32_dpp v15, v18 row_shr:4 row_mask:0xf bank_mask:0xa
  v_and_b32 v24, v15, v4
  v_and_b32 v25, v15, v5
  v_and_b32 v26, v15, v6
  v_and_b32 v27, v15, v7
  s_waitcnt vmcnt(5)
  s_nop 0
  v_mfma_f32_16x16x32_bf16 v[32:35], v[24:27], v[64:67], v[32:35]
  buffer_load_dwordx4 v[80:83], v10, s[12:15], s72 offen offset:1536 nt
  s_waitcnt vmcnt(5)
  v_mfma_f32_16x16x32_bf16 v[36:39], v[24:27], v[68:71], v[36:39]
  buffer_load_dwordx4 v[84:87], v11, s[12:15], s71 offen offset:1536 nt
  s_waitcnt vmcnt(4)
  v_mfma_f32_16x16x32_bf16 v[40:43], v[24:27], v[72:75], v[40:43]
  buffer_load_dwordx4 v[208:211], v12, s[20:23], s64 offen offset:768 sc1
  s_add_u32 s71, s67, 24
  s_and_b32 s71, s71, 63
  s_mul_i32 s71, s71, 6144
  s_add_u32 s71, s71, s73
  s_add_u32 s72, s71, 3072
  buffer_load_dwordx4 v[88:91], v10, s[12:15], s71 offen offset:0 nt
  v_mov_b32 v15, v18
  s_nop 1
  v_mov_b32_dpp v15, v18 row_shl:4 row_mask:0xf bank_mask:0x5
  v_and_b32 v28, v15, v4
  v_and_b32 v29, v15, v5
  v_and_b32 v30, v15, v6
  v_and_b32 v31, v15, v7
  s_waitcnt vmcnt(5)
  s_nop 0
  v_mfma_f32_16x16x32_bf16 v[32:35], v[28:31], v[76:79], v[32:35]
  buffer_load_dwordx4 v[212:215], v12, s[20:23], s40 offen offset:3328 sc1
  s_waitcnt vmcnt(4)
  v_mfma_f32_16x16x32_bf16 v[36:39], v[28:31], v[80:83], v[36:39]
  buffer_load_dwordx4 v[92:95], v10, s[12:15], s72 offen offset:0 nt
  buffer_load_dwordx4 v[96:99], v11, s[12:15], s71 offen offset:0 nt
  s_waitcnt vmcnt(5)
  v_mfma_f32_16x16x32_bf16 v[40:43], v[28:31], v[84:87], v[40:43]
  buffer_load_dwordx4 v[216:219], v12, s[20:23], s64 offen offset:3328 sc1
  v_or3_b32 v15, v4, v5, v6
  v_or_b32 v15, v15, v7
  v_and_b32 v15, v15, v14
  s_mov_b32 s44, 0x30003
  s_mov_b32 s45, 0x30003
  v_cndmask_b32 v24, 0, v15, s[44:45]
  s_mov_b32 s44, 0x300030
  s_mov_b32 s45, 0x300030
  v_cndmask_b32 v25, 0, v15, s[44:45]
  s_mov_b32 s44, 0x3000300
  s_mov_b32 s45, 0x3000300
  v_cndmask_b32 v26, 0, v15, s[44:45]
  s_mov_b32 s44, 0x30003000
  s_mov_b32 s45, 0x30003000
  v_cndmask_b32 v27, 0, v15, s[44:45]
  s_waitcnt vmcnt(17)
  s_nop 0
  v_mfma_f32_16x16x32_bf16 v[44:47], v[24:27], v[112:115], 0
  v_mfma_f32_16x16x32_bf16 v[48:51], v[24:27], v[116:119], 0
  v_mfma_f32_16x16x32_bf16 v[52:55], v[24:27], v[120:123], 0
  v_mfma_f32_16x16x32_bf16 v[56:59], v[24:27], v[124:127], 0
  v_mfma_f32_16x16x32_bf16 v[60:63], v[24:27], v[128:131], 0
  v_mov_b32 v15, v19
  s_nop 1
  v_mov_b32_dpp v15, v19 row_shr:4 row_mask:0xf bank_mask:0xa
  v_and_b32 v24, v15, v4
  v_and_b32 v25, v15, v5
  v_and_b32 v26, v15, v6
  v_and_b32 v27, v15, v7
  s_waitcnt vmcnt(4)
  s_nop 0
  v_mfma_f32_16x16x32_bf16 v[32:35], v[24:27], v[88:91], v[32:35]
  buffer_load_dwordx4 v[100:103], v10, s[12:15], s71 offen offset:1536 nt
  buffer_load_dwordx4 v[104:107], v10, s[12:15], s72 offen offset:1536 nt
  s_waitcnt vmcnt(4)
  v_mfma_f32_16x16x32_bf16 v[36:39], v[24:27], v[92:95], v[36:39]
  buffer_load_dwordx4 v[220:223], v12, s[20:23], s41 offen offset:768 sc1
  buffer_load_dwordx4 v[108:111], v11, s[12:15], s71 offen offset:1536 nt
  s_waitcnt vmcnt(5)
  v_mfma_f32_16x16x32_bf16 v[40:43], v[24:27], v[96:99], v[40:43]
  buffer_load_dwordx4 v[224:227], v12, s[20:23], s65 offen offset:768 sc1
  v_mov_b32 v15, v19
  s_nop 1
  v_mov_b32_dpp v15, v19 row_shl:4 row_mask:0xf bank_mask:0x5
  v_and_b32 v28, v15, v4
  v_and_b32 v29, v15, v5
  v_and_b32 v30, v15, v6
  v_and_b32 v31, v15, v7
  s_waitcnt vmcnt(4)
  s_nop 0
  v_mfma_f32_16x16x32_bf16 v[32:35], v[28:31], v[100:103], v[32:35]
  s_add_u32 s71, s67, 32
  s_and_b32 s71, s71, 63
  s_mul_i32 s71, s71, 6144
  s_add_u32 s71, s71, s73
  s_add_u32 s72, s71, 3072
  buffer_load_dwordx4 v[64:67], v10, s[12:15], s71 offen offset:0 nt
  buffer_load_dwordx4 v[68:71], v10, s[12:15], s72 offen offset:0 nt
  s_waitcnt vmcnt(5)
  v_mfma_f32_16x16x32_bf16 v[36:39], v[28:31], v[104:107], v[36:39]
  buffer_load_dwordx4 v[228:231], v12, s[20:23], s40 offen offset:1024 sc1
  s_waitcnt vmcnt(4)
  v_mfma_f32_16x16x32_bf16 v[40:43], v[28:31], v[108:111], v[40:43]
  buffer_load_dwordx4 v[72:75], v11, s[12:15], s71 offen offset:0 nt
  buffer_load_dwordx4 v[76:79], v10, s[12:15], s71 offen offset:1536 nt
  v_mov_b32 v15, v20
  s_nop 1
  v_mov_b32_dpp v15, v20 row_shr:4 row_mask:0xf bank_mask:0xa
  v_and_b32 v24, v15, v4
  v_and_b32 v25, v15, v5
  v_and_b32 v26, v15, v6
  v_and_b32 v27, v15, v7
  s_waitcnt vmcnt(4)
  s_nop 0
  v_mfma_f32_16x16x32_bf16 v[32:35], v[24:27], v[64:67], v[32:35]
  buffer_load_dwordx4 v[232:235], v12, s[20:23], s64 offen offset:1024 sc1
  buffer_load_dwordx4 v[80:83], v10, s[12:15], s72 offen offset:1536 nt
  s_waitcnt vmcnt(5)
  v_mfma_f32_16x16x32_bf16 v[36:39], v[24:27], v[68:71], v[36:39]
  v_and_b32 v8, 1, v1
  v_lshlrev_b32 v8, 7, v8
  s_mul_i32 s95, s69, 43691
  s_lshr_b32 s95, s95, 17
  s_mul_i32 s74, s5, 1280
  s_lshl_b32 s75, s95, 6
  s_add_u32 s96, s74, s75
  s_mul_i32 s74, s95, 3
  s_mov_b32 s97, 1
  s_cmp_lg_u32 s74, s69
  s_cselect_b32 s97, 0, s97
  s_cmp_ge_u32 s95, 20
  s_cselect_b32 s97, 0, s97
  s_cmp_lg_u32 s3, 7
  s_cselect_b32 s97, 0, s97
  v_lshlrev_b32 v9, 9, v1
  s_mov_b32 s98, 1048576
  s_cmp_eq_u32 s2, 0
  s_cselect_b32 s99, s97, 0
  s_cmp_eq_u32 s99, 0
  s_cbranch_scc1 L_nogf
  buffer_load_dword v124, v9, s[32:35], s98 offen offset:4 sc1
  buffer_load_dword v125, v9, s[32:35], s98 offen offset:132 sc1
  buffer_load_dword v126, v9, s[32:35], s98 offen offset:260 sc1
  buffer_load_dword v127, v9, s[32:35], s98 offen offset:388 sc1
L_nogf:
  buffer_load_dwordx4 v[252:255], v8, s[32:35], s91 offen sc1
  s_waitcnt vmcnt(4)
  v_mfma_f32_16x16x32_bf16 v[40:43], v[24:27], v[72:75], v[40:43]
  buffer_load_dwordx4 v[236:239], v12, s[20:23], s40 offen offset:3584 sc1
  buffer_load_dwordx4 v[84:87], v11, s[12:15], s71 offen offset:1536 nt
  v_mov_b32 v15, v20
  s_nop 1
  v_mov_b32_dpp v15, v20 row_shl:4 row_mask:0xf bank_mask:0x5
  v_and_b32 v28, v15, v4
  v_and_b32 v29, v15, v5
  v_and_b32 v30, v15, v6
  v_and_b32 v31, v15, v7
  s_waitcnt vmcnt(5)
  s_nop 0
  v_mfma_f32_16x16x32_bf16 v[32:35], v[28:31], v[76:79], v[32:35]
  s_add_u32 s71, s67, 40
  s_and_b32 s71, s71, 63
  s_mul_i32 s71, s71, 6144
  s_add_u32 s71, s71, s73
  s_add_u32 s72, s71, 3072
  buffer_load_dwordx4 v[88:91], v10, s[12:15], s71 offen offset:0 nt
  s_waitcnt vmcnt(4)
  v_mfma_f32_16x16x32_bf16 v[36:39], v[28:31], v[80:83], v[36:39]
  buffer_load_dwordx4 v[240:243], v12, s[20:23], s64 offen offset:3584 sc1
  buffer_load_dwordx4 v[92:95], v10, s[12:15], s72 offen offset:0 nt
  s_waitcnt vmcnt(3)
  v_mfma_f32_16x16x32_bf16 v[40:43], v[28:31], v[84:87], v[40:43]
  buffer_load_dwordx4 v[96:99], v11, s[12:15], s71 offen offset:0 nt
  buffer_load_dwordx4 v[244:247], v12, s[20:23], s41 offen offset:1024 sc1
  buffer_load_dwordx4 v[100:103], v10, s[12:15], s71 offen offset:1536 nt
  buffer_load_dwordx4 v[248:251], v12, s[20:23], s65 offen offset:1024 sc1
  buffer_load_dwordx4 v[104:107], v10, s[12:15], s72 offen offset:1536 nt
  buffer_load_dwordx4 v[108:111], v11, s[12:15], s71 offen offset:1536 nt
  s_add_u32 s71, s67, 48
  s_and_b32 s71, s71, 63
  s_mul_i32 s71, s71, 6144
  s_add_u32 s71, s71, s73
  s_add_u32 s72, s71, 3072
  buffer_load_dwordx4 v[64:67], v10, s[12:15], s71 offen offset:0 nt
  buffer_load_dwordx4 v[68:71], v10, s[12:15], s72 offen offset:0 nt
  buffer_load_dwordx4 v[72:75], v11, s[12:15], s71 offen offset:0 nt
  v_mov_b32 v15, v21
  s_nop 1
  v_mov_b32_dpp v15, v21 row_shr:4 row_mask:0xf bank_mask:0xa
  v_and_b32 v24, v15, v4
  v_and_b32 v25, v15, v5
  v_and_b32 v26, v15, v6
  v_and_b32 v27, v15, v7
  s_waitcnt vmcnt(11)
  s_nop 0
  v_mfma_f32_16x16x32_bf16 v[32:35], v[24:27], v[88:91], v[32:35]
  buffer_load_dwordx4 v[76:79], v10, s[12:15], s71 offen offset:1536 nt
  s_waitcnt vmcnt(10)
  v_mfma_f32_16x16x32_bf16 v[36:39], v[24:27], v[92:95], v[36:39]
  buffer_load_dwordx4 v[80:83], v10, s[12:15], s72 offen offset:1536 nt
  buffer_load_dwordx4 v[84:87], v11, s[12:15], s71 offen offset:1536 nt
  s_waitcnt vmcnt(11)
  v_mfma_f32_16x16x32_bf16 v[40:43], v[24:27], v[96:99], v[40:43]
  s_add_u32 s71, s67, 56
  s_and_b32 s71, s71, 63
  s_mul_i32 s71, s71, 6144
  s_add_u32 s71, s71, s73
  s_add_u32 s72, s71, 3072
  buffer_load_dwordx4 v[88:91], v10, s[12:15], s71 offen offset:0 nt
  v_mov_b32 v15, v21
  s_nop 1
  v_mov_b32_dpp v15, v21 row_shl:4 row_mask:0xf bank_mask:0x5
  v_and_b32 v28, v15, v4
  v_and_b32 v29, v15, v5
  v_and_b32 v30, v15, v6
  v_and_b32 v31, v15, v7
  s_waitcnt vmcnt(10)
  s_nop 0
  v_mfma_f32_16x16x32_bf16 v[32:35], v[28:31], v[100:103], v[32:35]
  buffer_load_dwordx4 v[92:95], v10, s[12:15], s72 offen offset:0 nt
  buffer_load_dwordx4 v[96:99], v11, s[12:15], s71 offen offset:0 nt
  s_waitcnt vmcnt(10)
  v_mfma_f32_16x16x32_bf16 v[36:39], v[28:31], v[104:107], v[36:39]
  buffer_load_dwordx4 v[100:103], v10, s[12:15], s71 offen offset:1536 nt
  buffer_load_dwordx4 v[104:107], v10, s[12:15], s72 offen offset:1536 nt
  s_waitcnt vmcnt(11)
  v_mfma_f32_16x16x32_bf16 v[40:43], v[28:31], v[108:111], v[40:43]
  buffer_load_dwordx4 v[108:111], v11, s[12:15], s71 offen offset:1536 nt
  s_mov_b32 s75, 524288
  s_waitcnt vmcnt(23)
L_spin2:
  v_cmp_ne_u32 vcc, s100, v253
  v_cmp_ne_u32 s[44:45], s101, v255
  s_nop 1
  s_or_b64 vcc, vcc, s[44:45]
  s_cbranch_scc0 L_ok2
  s_sub_u32 s75, s75, 1
  s_cbranch_scc1 L_ok2
  s_sleep 4
  buffer_load_dwordx4 v[252:255], v8, s[32:35], s91 offen sc1
  s_waitcnt vmcnt(0)
  s_nop 11
  s_branch L_spin2
L_ok2:
  s_cmp_eq_u32 s99, 0
  s_cbranch_scc1 L_ok2b
  s_mov_b32 s75, 524288
L_spin2b:
  v_cmp_ne_u32 vcc, s100, v124
  v_cmp_ne_u32 s[44:45], s100, v125
  v_cmp_ne_u32 s[46:47], s100, v126
  v_cmp_ne_u32 s[48:49], s100, v127
  s_or_b64 vcc, vcc, s[44:45]
  s_nop 0
  s_or_b64 s[46:47], s[46:47], s[48:49]
  s_or_b64 vcc, vcc, s[46:47]
  s_cbranch_scc0 L_ok2c
  s_sub_u32 s75, s75, 1
  s_cbranch_scc1 L_ok2c
  s_sleep 8
  buffer_load_dword v124, v9, s[32:35], s98 offen offset:4 sc1
  buffer_load_dword v125, v9, s[32:35], s98 offen offset:132 sc1
  buffer_load_dword v126, v9, s[32:35], s98 offen offset:260 sc1
  buffer_load_dword v127, v9, s[32:35], s98 offen offset:388 sc1
  s_waitcnt vmcnt(0)
  s_nop 11
  s_branch L_spin2b
L_ok2c:
  s_mov_b32 s76, 983040
  v_mov_b32 v124, s100
  v_mov_b32 v125, s101
  s_mov_b64 exec, 1
  buffer_store_dwordx2 v[124:125], v9, s[32:35], s76 offen sc1
  s_mov_b64 exec, -1
L_ok2b:
  v_mov_b32 v118, v252
  s_nop 1
  v_max_f32_dpp v118, v118, v118 row_ror:1 row_mask:0xf bank_mask:0xf
  v_sub_f32 v112, v252, v118
  v_sub_f32 v119, s88, v118
  v_mul_f32 v112, 0x3fb8aa3b, v112
  v_mul_f32 v119, 0x3fb8aa3b, v119
  v_exp_f32 v112, v112
  v_exp_f32 v119, v119
  v_mul_f32 v112, v112, v254
  s_nop 1
  v_add_f32_dpp v112, v112, v112 row_ror:1 row_mask:0xf bank_mask:0xf
  v_rcp_f32 v112, v112
  s_nop 0
  v_mul_f32 v14, v112, v119
  v_mul_f32 v32, v32, v14
  v_mul_f32 v33, v33, v14
  v_mul_f32 v34, v34, v14
  v_mul_f32 v35, v35, v14
  v_mul_f32 v36, v36, v14
  v_mul_f32 v37, v37, v14
  v_mul_f32 v38, v38, v14
  v_mul_f32 v39, v39, v14
  v_mul_f32 v40, v40, v14
  v_mul_f32 v41, v41, v14
  v_mul_f32 v42, v42, v14
  v_mul_f32 v43, v43, v14
  v_mul_f32 v22, v22, v14
  v_cvt_pk_bf16_f32 v22, v22, v22
  v_mul_f32 v23, v23, v14
  v_cvt_pk_bf16_f32 v23, v23, v23
  v_and_b32 v117, 7, v1
  v_lshlrev_b32 v117, 3, v117
  v_and_b32 v115, 1, v3
  v_lshlrev_b32 v115, 2, v115
  v_and_b32 v116, 2, v3
  v_add3_u32 v115, v115, v116, v117
  s_min_u32 s74, s96, 5056
  v_add_u32 v116, s74, v115
  ds_read_u16 v114, v116 offset:16128
  v_lshrrev_b32 v118, 1, v3
  v_lshrrev_b32 v126, 3, v1
  v_mul_u32_u24 v126, 2560, v126
  v_and_b32 v117, 7, v1
  v_lshl_add_u32 v126, v117, 4, v126
  s_mul_i32 s94, s5, 163840
  s_lshl_b32 s74, s95, 7
  s_add_u32 s94, s94, s74
  s_add_u32 s48, s94, 0
  s_add_u32 s49, s94, 20480
  s_add_u32 s50, s94, 40960
  s_add_u32 s51, s94, 61440
  s_add_u32 s52, s94, 81920
  s_add_u32 s53, s94, 102400
  s_add_u32 s54, s94, 122880
  s_add_u32 s55, s94, 143360
  v_and_b32 v119, 1, v3
  v_lshl_add_u32 v120, v2, 1, v119
  v_and_b32 v121, 15, v120
  v_add_u32 v121, 32, v121
  v_and_b32 v119, 2, v3
  s_lshl_b32 s74, s3, 2
  v_add_u32 v119, s74, v119
  s_movk_i32 s76, 136
  v_mad_u32_u24 v120, v120, s76, v119
  v_mad_u32_u24 v121, v121, s76, v119
  v_lshrrev_b32 v119, 3, v2
  v_cmp_eq_u32 vcc, v119, v118
  v_lshlrev_b32 v119, 2, v1
  v_add_u32 v119, 14336, v119
  v_cndmask_b32 v121, v119, v121, vcc
  v_lshrrev_b32 v119, 2, v2
  v_mul_u32_u24 v119, 6, v119
  s_mul_i32 s74, s3, 24
  v_add_u32 v119, s74, v119
  v_and_b32 v122, 3, v2
  v_add_u32 v122, v122, v119
  v_and_b32 v131, 1, v2
  v_add3_u32 v131, v131, v119, 4
  v_lshrrev_b32 v119, 2, v122
  v_lshlrev_b32 v119, 3, v119
  v_lshl_add_u32 v122, v122, 5, v119
  v_lshl_add_u32 v122, v3, 3, v122
  v_lshrrev_b32 v119, 2, v131
  v_lshlrev_b32 v119, 3, v119
  v_lshl_add_u32 v131, v131, 5, v119
  v_lshl_add_u32 v131, v3, 3, v131
  v_mov_b32 v112, 0x3f803f80
  v_mov_b32 v113, 0x3f803f80
  s_mov_b32 s44, 0x00330033
  s_mov_b32 s45, 0x00330033
  s_mov_b32 s46, 0x33003300
  s_mov_b32 s47, 0x33003300
  v_bfe_u32 v119, v2, 2, 1
  v_and_b32 v127, 1, v2
  v_lshl_add_u32 v127, v119, 1, v127
  v_mul_u32_u24 v127, 0x5555, v127
  v_mul_u32_u24 v123, 192, v3
  v_lshl_add_u32 v123, v2, 3, v123
  s_mul_i32 s74, s3, 3840
  v_add_u32 v123, s74, v123
  v_and_b32 v119, 3, v1
  v_mul_u32_u24 v124, 192, v119
  v_lshrrev_b32 v119, 2, v1
  v_lshl_add_u32 v124, v119, 3, v124
  s_mul_i32 s74, s3, 768
  v_add_u32 v124, s74, v124
  v_and_b32 v119, 1, v1
  s_lshl_b32 s74, s3, 9
  v_lshl_add_u32 v125, v1, 3, s74
  v_cmp_eq_u32 vcc, 1, v119
  v_mov_b32 v130, s70
  v_mov_b32 v119, s7
  v_cndmask_b32 v130, v130, v119, vcc
  s_movk_i32 s98, 0xff
  v_mov_b32 v128, s70
  v_mov_b32 v129, s7
  v_mov_b32 v15, v22
  s_nop 1
  v_mov_b32_dpp v15, v22 row_shr:4 row_mask:0xf bank_mask:0xa
  v_and_b32 v24, v15, v4
  v_and_b32 v25, v15, v5
  v_and_b32 v26, v15, v6
  v_and_b32 v27, v15, v7
  s_waitcnt vmcnt(11)
  s_nop 0
  v_mfma_f32_16x16x32_bf16 v[32:35], v[24:27], v[64:67], v[32:35]
  s_waitcnt vmcnt(10)
  v_mfma_f32_16x16x32_bf16 v[36:39], v[24:27], v[68:71], v[36:39]
  s_waitcnt vmcnt(9)
  v_mfma_f32_16x16x32_bf16 v[40:43], v[24:27], v[72:75], v[40:43]
  v_mov_b32 v15, v22
  s_nop 1
  v_mov_b32_dpp v15, v22 row_shl:4 row_mask:0xf bank_mask:0x5
  v_and_b32 v28, v15, v4
  v_and_b32 v29, v15, v5
  v_and_b32 v30, v15, v6
  v_and_b32 v31, v15, v7
  s_waitcnt vmcnt(8)
  s_nop 0
  v_mfma_f32_16x16x32_bf16 v[32:35], v[28:31], v[76:79], v[32:35]
  s_waitcnt vmcnt(7)
  v_mfma_f32_16x16x32_bf16 v[36:39], v[28:31], v[80:83], v[36:39]
  s_waitcnt vmcnt(6)
  v_mfma_f32_16x16x32_bf16 v[40:43], v[28:31], v[84:87], v[40:43]
  v_mov_b32 v12, 0xffff
  v_mov_b32 v13, 0xffff0000
  v_cndmask_b32 v8, 0, v12, s[44:45]
  v_cndmask_b32 v9, 0, v12, s[46:47]
  v_cndmask_b32 v10, 0, v13, s[44:45]
  v_cndmask_b32 v11, 0, v13, s[46:47]
  v_mov_b32 v15, v23
  s_nop 1
  v_mov_b32_dpp v15, v23 row_shr:4 row_mask:0xf bank_mask:0xa
  v_and_b32 v24, v15, v4
  v_and_b32 v25, v15, v5
  v_and_b32 v26, v15, v6
  v_and_b32 v27, v15, v7
  s_waitcnt vmcnt(5)
  s_nop 0
  v_mfma_f32_16x16x32_bf16 v[32:35], v[24:27], v[88:91], v[32:35]
  s_waitcnt vmcnt(4)
  v_mfma_f32_16x16x32_bf16 v[36:39], v[24:27], v[92:95], v[36:39]
  s_waitcnt vmcnt(3)
  v_mfma_f32_16x16x32_bf16 v[40:43], v[24:27], v[96:99], v[40:43]
  v_mov_b32 v15, v23
  s_nop 1
  v_mov_b32_dpp v15, v23 row_shl:4 row_mask:0xf bank_mask:0x5
  v_and_b32 v28, v15, v4
  v_and_b32 v29, v15, v5
  v_and_b32 v30, v15, v6
  v_and_b32 v31, v15, v7
  s_waitcnt vmcnt(2)
  s_nop 0
  v_mfma_f32_16x16x32_bf16 v[32:35], v[28:31], v[100:103], v[32:35]
  s_waitcnt vmcnt(1)
  v_mfma_f32_16x16x32_bf16 v[36:39], v[28:31], v[104:107], v[36:39]
  s_waitcnt vmcnt(0)
  v_mfma_f32_16x16x32_bf16 v[40:43], v[28:31], v[108:111], v[40:43]
  s_nop 3
  v_cvt_pk_bf16_f32 v24, v32, v33
  v_cvt_pk_bf16_f32 v25, v34, v35
  v_cvt_pk_bf16_f32 v26, v36, v37
  v_cvt_pk_bf16_f32 v27, v38, v39
  v_cndmask_b32 v24, v26, v24, s[78:79]
  v_cndmask_b32 v25, v27, v25, s[78:79]
  ds_write_b16 v120, v24 offset:0
  ds_write_b16_d16_hi v120, v24 offset:32
  ds_write_b16 v120, v25 offset:64
  ds_write_b16_d16_hi v120, v25 offset:96
  v_cvt_pk_bf16_f32 v26, v40, v41
  v_cvt_pk_bf16_f32 v27, v42, v43
  ds_write_b16 v121, v26 offset:0
  ds_write_b16_d16_hi v121, v26 offset:32
  ds_write_b16 v121, v27 offset:64
  ds_write_b16_d16_hi v121, v27 offset:96
  s_waitcnt lgkmcnt(0)
  s_barrier
  ds_read_b64 v[24:25], v122
  ds_read_b64 v[26:27], v131
  s_waitcnt lgkmcnt(1)
  v_mfma_f32_16x16x16_bf16 v[16:19], v[24:25], v[112:113], 0
  s_waitcnt lgkmcnt(0)
  v_mfma_f32_16x16x16_bf16 v[20:23], v[26:27], v[112:113], 0
  s_nop 5
  v_cvt_pk_bf16_f32 v16, v16, v17
  v_and_b32 v64, v16, v8
  v_and_b32 v65, v16, v9
  v_and_b32 v66, v16, v10
  v_and_b32 v67, v16, v11
  s_nop 1
  v_smfmac_f32_16x16x64_bf16 v[44:47], v[64:67], v[132:139], v127
  v_cvt_pk_bf16_f32 v18, v18, v19
  v_and_b32 v68, v18, v8
  v_and_b32 v69, v18, v9
  v_and_b32 v70, v18, v10
  v_and_b32 v71, v18, v11
  v_smfmac_f32_16x16x64_bf16 v[48:51], v[64:67], v[156:163], v127
  v_cvt_pk_bf16_f32 v20, v20, v21
  v_and_b32 v72, v20, v8
  v_and_b32 v73, v20, v9
  v_and_b32 v74, v20, v10
  v_and_b32 v75, v20, v11
  v_smfmac_f32_16x16x64_bf16 v[44:47], v[68:71], v[140:147], v127
  v_smfmac_f32_16x16x64_bf16 v[52:55], v[64:67], v[180:187], v127
  v_smfmac_f32_16x16x64_bf16 v[44:47], v[72:75], v[148:155], v127
  v_smfmac_f32_16x16x64_bf16 v[48:51], v[68:71], v[164:171], v127
  v_smfmac_f32_16x16x64_bf16 v[52:55], v[68:71], v[188:195], v127
  v_smfmac_f32_16x16x64_bf16 v[48:51], v[72:75], v[172:179], v127
  v_smfmac_f32_16x16x64_bf16 v[56:59], v[64:67], v[204:211], v127
  s_nop 3
  ds_write_b64 v123, v[44:45] offset:21504
  v_smfmac_f32_16x16x64_bf16 v[52:55], v[72:75], v[196:203], v127
  v_smfmac_f32_16x16x64_bf16 v[56:59], v[68:71], v[212:219], v127
  ds_write_b64 v123, v[48:49] offset:22272
  v_smfmac_f32_16x16x64_bf16 v[60:63], v[64:67], v[228:235], v127
  v_smfmac_f32_16x16x64_bf16 v[56:59], v[72:75], v[220:227], v127
  s_nop 3
  ds_write_b64 v123, v[52:53] offset:23040
  v_smfmac_f32_16x16x64_bf16 v[60:63], v[68:71], v[236:243], v127
  v_smfmac_f32_16x16x64_bf16 v[60:63], v[72:75], v[244:251], v127
  s_nop 0
  ds_write_b64 v123, v[56:57] offset:23808
  s_nop 5
  ds_write_b64 v123, v[60:61] offset:24576
  s_waitcnt lgkmcnt(0)
  s_barrier
  s_cmp_ge_u32 s3, 5
  s_cbranch_scc1 L_cons
  ds_read_b64 v[16:17], v124 offset:21504
  ds_read_b64 v[18:19], v124 offset:25344
  ds_read_b64 v[20:21], v124 offset:29184
  ds_read_b64 v[22:23], v124 offset:33024
  ds_read_b64 v[24:25], v124 offset:36864
  ds_read_b64 v[26:27], v124 offset:40704
  ds_read_b64 v[28:29], v124 offset:44544
  ds_read_b64 v[30:31], v124 offset:48384
  s_waitcnt lgkmcnt(6)
  v_pk_add_f32 v[16:17], v[16:17], v[18:19]
  s_waitcnt lgkmcnt(4)
  v_pk_add_f32 v[20:21], v[20:21], v[22:23]
  v_pk_add_f32 v[16:17], v[16:17], v[20:21]
  s_waitcnt lgkmcnt(2)
  v_pk_add_f32 v[24:25], v[24:25], v[26:27]
  s_waitcnt lgkmcnt(0)
  v_pk_add_f32 v[28:29], v[28:29], v[30:31]
  v_pk_add_f32 v[24:25], v[24:25], v[28:29]
  v_pk_add_f32 v[16:17], v[16:17], v[24:25]
  v_bfi_b32 v16, s98, v130, v16
  buffer_store_dwordx2 v[16:17], v125, s[32:35], s90 offen sc1
  s_endpgm
L_cons:
  s_cmp_eq_u32 s97, 0
  s_cbranch_scc1 L_fin
  s_mov_b32 s75, 524288
  buffer_load_dwordx4 v[16:19], v126, s[32:35], s48 offen sc1
  buffer_load_dwordx4 v[20:23], v126, s[32:35], s49 offen sc1
  buffer_load_dwordx4 v[24:27], v126, s[32:35], s50 offen sc1
  buffer_load_dwordx4 v[28:31], v126, s[32:35], s51 offen sc1
  buffer_load_dwordx4 v[32:35], v126, s[32:35], s52 offen sc1
  buffer_load_dwordx4 v[36:39], v126, s[32:35], s53 offen sc1
  buffer_load_dwordx4 v[40:43], v126, s[32:35], s54 offen sc1
  buffer_load_dwordx4 v[44:47], v126, s[32:35], s55 offen sc1
L_spin3:
  buffer_load_dwordx4 v[68:71], v126, s[32:35], s48 offen sc1
  buffer_load_dwordx4 v[72:75], v126, s[32:35], s49 offen sc1
  buffer_load_dwordx4 v[76:79], v126, s[32:35], s50 offen sc1
  buffer_load_dwordx4 v[80:83], v126, s[32:35], s51 offen sc1
  buffer_load_dwordx4 v[84:87], v126, s[32:35], s52 offen sc1
  buffer_load_dwordx4 v[88:91], v126, s[32:35], s53 offen sc1
  buffer_load_dwordx4 v[92:95], v126, s[32:35], s54 offen sc1
  buffer_load_dwordx4 v[96:99], v126, s[32:35], s55 offen sc1
  s_waitcnt vmcnt(15)
  v_xor_b32 v16, v16, v128
  v_xor_b32 v18, v18, v129
  v_or_b32 v15, v16, v18
  s_waitcnt vmcnt(14)
  v_xor_b32 v20, v20, v128
  v_xor_b32 v22, v22, v129
  v_or3_b32 v15, v15, v20, v22
  s_waitcnt vmcnt(13)
  v_xor_b32 v24, v24, v128
  v_xor_b32 v26, v26, v129
  v_or3_b32 v15, v15, v24, v26
  s_waitcnt vmcnt(12)
  v_xor_b32 v28, v28, v128
  v_xor_b32 v30, v30, v129
  v_or3_b32 v15, v15, v28, v30
  s_waitcnt vmcnt(11)
  v_xor_b32 v32, v32, v128
  v_xor_b32 v34, v34, v129
  v_or3_b32 v15, v15, v32, v34
  s_waitcnt vmcnt(10)
  v_xor_b32 v36, v36, v128
  v_xor_b32 v38, v38, v129
  v_or3_b32 v15, v15, v36, v38
  s_waitcnt vmcnt(9)
  v_xor_b32 v40, v40, v128
  v_xor_b32 v42, v42, v129
  v_or3_b32 v15, v15, v40, v42
  s_waitcnt vmcnt(8)
  v_xor_b32 v44, v44, v128
  v_xor_b32 v46, v46, v129
  v_or3_b32 v15, v15, v44, v46
  v_and_b32 v15, s98, v15
  v_cmp_ne_u32 vcc, 0, v15
  s_nop 1
  s_cbranch_vccz L_ok3
  buffer_load_dwordx4 v[16:19], v126, s[32:35], s48 offen sc1
  buffer_load_dwordx4 v[20:23], v126, s[32:35], s49 offen sc1
  buffer_load_dwordx4 v[24:27], v126, s[32:35], s50 offen sc1
  buffer_load_dwordx4 v[28:31], v126, s[32:35], s51 offen sc1
  buffer_load_dwordx4 v[32:35], v126, s[32:35], s52 offen sc1
  buffer_load_dwordx4 v[36:39], v126, s[32:35], s53 offen sc1
  buffer_load_dwordx4 v[40:43], v126, s[32:35], s54 offen sc1
  buffer_load_dwordx4 v[44:47], v126, s[32:35], s55 offen sc1
  s_sub_u32 s75, s75, 1
  s_waitcnt vmcnt(15)
  v_xor_b32 v68, v68, v128
  v_xor_b32 v70, v70, v129
  v_or_b32 v15, v68, v70
  s_waitcnt vmcnt(14)
  v_xor_b32 v72, v72, v128
  v_xor_b32 v74, v74, v129
  v_or3_b32 v15, v15, v72, v74
  s_waitcnt vmcnt(13)
  v_xor_b32 v76, v76, v128
  v_xor_b32 v78, v78, v129
  v_or3_b32 v15, v15, v76, v78
  s_waitcnt vmcnt(12)
  v_xor_b32 v80, v80, v128
  v_xor_b32 v82, v82, v129
  v_or3_b32 v15, v15, v80, v82
  s_waitcnt vmcnt(11)
  v_xor_b32 v84, v84, v128
  v_xor_b32 v86, v86, v129
  v_or3_b32 v15, v15, v84, v86
  s_waitcnt vmcnt(10)
  v_xor_b32 v88, v88, v128
  v_xor_b32 v90, v90, v129
  v_or3_b32 v15, v15, v88, v90
  s_waitcnt vmcnt(9)
  v_xor_b32 v92, v92, v128
  v_xor_b32 v94, v94, v129
  v_or3_b32 v15, v15, v92, v94
  s_waitcnt vmcnt(8)
  v_xor_b32 v96, v96, v128
  v_xor_b32 v98, v98, v129
  v_or3_b32 v15, v15, v96, v98
  v_and_b32 v15, s98, v15
  v_cmp_ne_u32 vcc, 0, v15
  s_cbranch_scc1 L_ok3b
  s_nop 0
  s_and_b64 vcc, vcc, vcc
  s_cbranch_scc1 L_spin3
L_ok3b:
  v_pk_add_f32 v[68:69], v[68:69], v[84:85]
  v_pk_add_f32 v[70:71], v[70:71], v[86:87]
  v_pk_add_f32 v[72:73], v[72:73], v[88:89]
  v_pk_add_f32 v[74:75], v[74:75], v[90:91]
  v_pk_add_f32 v[76:77], v[76:77], v[92:93]
  v_pk_add_f32 v[78:79], v[78:79], v[94:95]
  v_pk_add_f32 v[80:81], v[80:81], v[96:97]
  v_pk_add_f32 v[82:83], v[82:83], v[98:99]
  v_pk_add_f32 v[68:69], v[68:69], v[76:77]
  v_pk_add_f32 v[70:71], v[70:71], v[78:79]
  v_pk_add_f32 v[72:73], v[72:73], v[80:81]
  v_pk_add_f32 v[74:75], v[74:75], v[82:83]
  v_pk_add_f32 v[68:69], v[68:69], v[72:73]
  v_pk_add_f32 v[70:71], v[70:71], v[74:75]
  v_lshlrev_b32 v14, 16, v114
  v_permlane32_swap_b32 v68, v69
  v_permlane32_swap_b32 v70, v71
  v_add_f32 v68, v68, v69
  v_add_f32 v70, v70, v71
  s_nop 1
  v_permlane16_swap_b32 v68, v70
  v_add_f32 v68, v68, v70
  s_nop 1
  v_add_f32_dpp v68, v68, v68 row_ror:8 row_mask:0xf bank_mask:0xf
  v_add_f32 v68, v68, v14
  v_cvt_pk_bf16_f32 v68, v68, v68
  s_mov_b32 exec_lo, 0x00ff00ff
  s_mov_b32 exec_hi, 0x00ff00ff
  buffer_store_short v68, v115, s[36:39], s96 offen
  s_mov_b64 exec, -1
  s_branch L_ok3c
L_ok3:
  v_pk_add_f32 v[16:17], v[16:17], v[32:33]
  v_pk_add_f32 v[18:19], v[18:19], v[34:35]
  v_pk_add_f32 v[20:21], v[20:21], v[36:37]
  v_pk_add_f32 v[22:23], v[22:23], v[38:39]
  v_pk_add_f32 v[24:25], v[24:25], v[40:41]
  v_pk_add_f32 v[26:27], v[26:27], v[42:43]
  v_pk_add_f32 v[28:29], v[28:29], v[44:45]
  v_pk_add_f32 v[30:31], v[30:31], v[46:47]
  v_pk_add_f32 v[16:17], v[16:17], v[24:25]
  v_pk_add_f32 v[18:19], v[18:19], v[26:27]
  v_pk_add_f32 v[20:21], v[20:21], v[28:29]
  v_pk_add_f32 v[22:23], v[22:23], v[30:31]
  v_pk_add_f32 v[16:17], v[16:17], v[20:21]
  v_pk_add_f32 v[18:19], v[18:19], v[22:23]
  v_lshlrev_b32 v14, 16, v114
  v_permlane32_swap_b32 v16, v17
  v_permlane32_swap_b32 v18, v19
  v_add_f32 v16, v16, v17
  v_add_f32 v18, v18, v19
  s_nop 1
  v_permlane16_swap_b32 v16, v18
  v_add_f32 v16, v16, v18
  s_nop 1
  v_add_f32_dpp v16, v16, v16 row_ror:8 row_mask:0xf bank_mask:0xf
  v_add_f32 v16, v16, v14
  v_cvt_pk_bf16_f32 v16, v16, v16
  s_mov_b32 exec_lo, 0x00ff00ff
  s_mov_b32 exec_hi, 0x00ff00ff
  buffer_store_short v16, v115, s[36:39], s96 offen
  s_mov_b64 exec, -1
L_ok3c:
L_fin:
L_end:
  s_endpgm
.section .rodata,"a"
.p2align 6
.amdhsa_kernel parallel_sum__sliding_block_cached__geglu_ffn__decode_kernel
  .amdhsa_next_free_vgpr 256
  .amdhsa_next_free_sgpr 102
  .amdhsa_accum_offset 256
  .amdhsa_group_segment_fixed_size 0
  .amdhsa_kernarg_size 96
  .amdhsa_user_sgpr_count 2
  .amdhsa_user_sgpr_kernarg_segment_ptr 1
  .amdhsa_system_sgpr_workgroup_id_x 1
  .amdhsa_float_denorm_mode_32 3
.end_amdhsa_kernel
```
